```python
import torch

def _softmax(x, axis=-1):
    return torch.softmax(x, dim=axis)

def _gelu(x):
    return torch.nn.functional.gelu(x, approximate='tanh')

def _silu(x):
    return torch.nn.functional.silu(x)

def _sigmoid(x):
    return torch.sigmoid(x)

def _layernorm(x, axis=-1, eps=1e-05):
    m = x.mean(dim=axis, keepdim=True)
    v = x.var(dim=axis, keepdim=True, unbiased=False)
    return (x - m) / torch.sqrt(v + eps)

def _scatter_add(tgt, idx, src, axis=0):
    return tgt.clone().index_add_(axis, idx, src)

def _segment_sum(src, seg, n):
    out = torch.zeros((n,) + src.shape[1:], dtype=src.dtype)
    return out.index_add_(0, seg, src)

def _pad(x, pw):
    flat = tuple((v for pair in reversed(pw) for v in pair))
    return torch.nn.functional.pad(x, flat)
kernel_name = 'parallel_sum__linear_attn_block__mixer_gmlp__prompt'

def setup_inputs():

    _w = lambda a: (lambda t: t.to(torch.bfloat16) if t.is_floating_point() else t)(torch.as_tensor(a))

    def _A_setup():
        B, S, D = (1, 2048, 640)
        return {'x': _w((lambda *s: torch.randn(*s, dtype=torch.bfloat16) * 0.05)(B, S, D)), 'wqkv': _w((lambda *s: torch.randn(*s, dtype=torch.bfloat16) * 0.8)(D, 3 * D)), 'wo': _w((lambda *s: torch.randn(*s, dtype=torch.bfloat16) * 0.2)(D, D))}
    _A_in = _A_setup()

    def _B_setup():
        B, S, D, F = (1, 2048, 640, 1536)
        Fh = F // 2
        return {'x': _w((lambda *s: torch.randn(*s, dtype=torch.bfloat16) * 0.05)(B, S, D)), 'w_in': _w((lambda *s: torch.randn(*s, dtype=torch.bfloat16) * 0.4)(D, 2 * Fh)), 'w_sp': _w(0.01 * (lambda *s: torch.randn(*s, dtype=torch.bfloat16) * 0.4)(S, S)), 'b_sp': _w(1.0 + 0.01 * (lambda *s: torch.randn(*s, dtype=torch.bfloat16) * 0.05)(S)), 'w_out': _w((lambda *s: torch.randn(*s, dtype=torch.bfloat16) * 0.05)(Fh, D))}
    _B_in = _B_setup()
    return {'A_x': _A_in['x'], 'A_wqkv': _A_in['wqkv'], 'A_wo': _A_in['wo'], 'B_x': _B_in['x'], 'B_w_in': _B_in['w_in'], 'B_w_sp': _B_in['w_sp'], 'B_b_sp': _B_in['b_sp'], 'B_w_out': _B_in['w_out']}

def reference(A_x, A_wqkv, A_wo, B_x, B_w_in, B_w_sp, B_b_sp, B_w_out):

    def _A_ref(x, wqkv, wo):
        B, S, D = x.shape
        H = 32
        Dh = D // H
        qkv = (lambda x, *d: x.permute(*d))((x @ wqkv).reshape(B, S, 3, H, Dh), 2, 0, 3, 1, 4)
        q, k, v = (qkv[0], qkv[1], qkv[2])
        phi = lambda t: torch.where(t > 0, t + 1, torch.exp(t)) + 1e-06
        pq, pk = (phi(q), phi(k))
        kv = torch.einsum('bhsd,bhse->bhde', pk, v)
        z = torch.einsum('bhsd->bhd', pk)
        num = torch.einsum('bhqd,bhde->bhqe', pq, kv)
        den = torch.einsum('bhqd,bhd->bhq', pq, z)[..., None] + 1e-06
        o = num / den
        return (lambda x, *d: x.permute(*d))(o, 0, 2, 1, 3).reshape(B, S, D) @ wo

    def _B_ref(x, w_in, w_sp, b_sp, w_out):
        B, S, D = x.shape
        F = w_in.shape[-1]
        Fh = F // 2
        z = _gelu(torch.einsum('bsd,df->bsf', x, w_in))
        z1 = z[..., :Fh].clone()
        z2 = _layernorm(z[..., Fh:], axis=-1)
        g = torch.einsum('ts,bsf->btf', w_sp, z2) + b_sp[None, :, None]
        return torch.einsum('bsf,fd->bsd', z1 * g, w_out)
    x = A_x
    xn = _layernorm(x, axis=-1)
    return x + _A_ref(xn, A_wqkv, A_wo) + _B_ref(xn, B_w_in, B_w_sp, B_b_sp, B_w_out)
```

```asm
; @launch kernel=k1_kernel grid=(256,1,1) block=(512,1,1) lds=137216
; @launch kernel=k2_kernel grid=(256,1,1) block=(512,1,1) lds=137216
; @launch kernel=k3_kernel grid=(256,1,1) block=(512,1,1) lds=98304
; @launch kernel=k4_kernel grid=(256,1,1) block=(512,1,1) lds=163840
.amdgcn_target "amdgcn-amd-amdhsa--gfx950"
.text
.globl k1_kernel
.p2align 8
.type k1_kernel,@function
k1_kernel:
    s_cmp_ge_u32 s2, 256
    s_cbranch_scc1 k1_done
    s_load_dwordx4 s[4:7], s[0:1], 0
    s_load_dwordx2 s[8:9], s[0:1], 32
    s_load_dwordx2 s[10:11], s[0:1], 80
    v_lshrrev_b32 v2, 6, v0
    s_nop 0
    v_readfirstlane_b32 s28, v2
    s_and_b32 s33, s2, 7
    s_lshr_b32 s34, s2, 3
    s_lshr_b32 s24, s33, 1
    s_lshl_b32 s24, s24, 2
    s_lshr_b32 s41, s34, 3
    s_add_u32 s24, s24, s41
    s_and_b32 s25, s33, 1
    s_lshl_b32 s25, s25, 3
    s_and_b32 s40, s34, 7
    s_add_u32 s25, s25, s40
    s_lshr_b32 s29, s28, 2
    s_and_b32 s30, s28, 3
    s_movk_i32 s26, 3840
    s_mov_b32 s18, 2457600
    s_movk_i32 s33, 1280
    s_cmp_lt_u32 s25, 10
    s_cselect_b32 s26, s26, 3072
    s_cselect_b32 s18, s18, 1966080
    s_cselect_b32 s33, s33, -1024
    s_lshl_b32 s27, s25, 8
    s_add_i32 s27, s27, s33
    s_mov_b32 s19, 0x00020000
    s_lshl_b32 s35, s28, 11
    s_lshl_b32 s38, s26, 6
    s_lshr_b32 s32, s2, 3
    s_mul_i32 s33, s32, 6554
    s_lshr_b32 s33, s33, 16
    s_mul_i32 s33, s33, 10
    s_sub_u32 s32, s32, s33
    v_and_b32 v1, 63, v0
    v_lshrrev_b32 v5, 3, v1
    s_lshl_b32 s33, s24, 7
    s_lshl_b32 s34, s28, 4
    s_add_u32 s33, s33, s34
    v_add_u32 v5, s33, v5
    s_movk_i32 s34, 1280
    v_mul_lo_u32 v5, v5, s34
    v_lshrrev_b32 v6, 4, v1
    v_and_b32 v7, 7, v1
    v_xor_b32 v8, v7, v6
    v_lshlrev_b32 v8, 4, v8
    v_add_u32 v176, v5, v8
    v_add_u32 v6, 4, v6
    v_xor_b32 v8, v7, v6
    v_lshlrev_b32 v8, 4, v8
    v_add_u32 v8, v5, v8
    v_add_u32 v177, 9216, v8
    v_lshrrev_b32 v6, 4, v1
    s_lshl_b32 s33, s28, 3
    v_add_u32 v5, s33, v6
    v_mul_lo_u32 v5, v5, s26
    v_and_b32 v7, 15, v1
    v_lshrrev_b32 v7, 2, v7
    v_xor_b32 v7, v7, v6
    v_lshlrev_b32 v7, 2, v7
    v_and_b32 v8, 3, v1
    v_add_u32 v7, v7, v8
    v_lshlrev_b32 v7, 4, v7
    v_add_u32 v5, v5, v7
    v_add_u32 v178, s27, v5
    s_lshl_b32 s33, s26, 2
    s_sub_u32 s33, s33, 1024
    v_add_u32 v179, s33, v178
    s_waitcnt lgkmcnt(0)
    s_cmp_lt_u32 s25, 10
    s_cselect_b32 s16, s6, s8
    s_cselect_b32 s17, s7, s9
    s_and_b32 s17, s17, 0xffff
    s_mov_b32 s12, s4
    s_and_b32 s13, s5, 0xffff
    s_mov_b32 s14, 2621440
    s_mov_b32 s15, 0x00020000
    s_add_u32 s48, s32, 0
    s_sub_u32 s49, s48, 10
    s_cmp_ge_u32 s48, 10
    s_cselect_b32 s48, s49, s48
    s_add_u32 m0, s35, 0
    s_lshl_b32 s36, s48, 7
    buffer_load_dwordx4 v176, s[12:15], s36 offen lds
    buffer_load_dwordx4 v177, s[12:15], s36 offen offset:1024 lds
    s_add_u32 m0, s35, 16384
    s_mul_i32 s37, s38, s48
    buffer_load_dwordx4 v178, s[16:19], s37 offen lds
    buffer_load_dwordx4 v179, s[16:19], s37 offen offset:1024 lds
    s_add_u32 s48, s32, 1
    s_sub_u32 s49, s48, 10
    s_cmp_ge_u32 s48, 10
    s_cselect_b32 s48, s49, s48
    s_add_u32 m0, s35, 32768
    s_lshl_b32 s36, s48, 7
    buffer_load_dwordx4 v176, s[12:15], s36 offen lds
    buffer_load_dwordx4 v177, s[12:15], s36 offen offset:1024 lds
    s_add_u32 m0, s35, 49152
    s_mul_i32 s37, s38, s48
    buffer_load_dwordx4 v178, s[16:19], s37 offen lds
    buffer_load_dwordx4 v179, s[16:19], s37 offen offset:1024 lds
    s_mov_b32 s20, s10
    s_and_b32 s21, s11, 0xffff
    s_mov_b32 s22, 25182208
    s_mov_b32 s23, 0x00020000
    v_and_b32 v2, 31, v1
    v_lshrrev_b32 v3, 5, v1
    v_lshrrev_b32 v4, 1, v1
    v_and_b32 v4, 7, v4
    v_xor_b32 v4, v3, v4
    v_lshlrev_b32 v4, 4, v4
    v_lshlrev_b32 v5, 7, v2
    v_add_u32 v4, v4, v5
    s_lshl_b32 s33, s29, 13
    v_add_u32 v4, s33, v4
    s_xor_b32 s31, s30, s29
    s_lshl_b32 s33, s31, 5
    v_xor_b32 v4, s33, v4
    v_xor_b32 v160, 0, v4
    v_add_u32 v164, 0x10000, v160
    v_xor_b32 v161, 32, v4
    v_add_u32 v165, 0x10000, v161
    v_xor_b32 v162, 64, v4
    v_add_u32 v166, 0x10000, v162
    v_xor_b32 v163, 96, v4
    v_add_u32 v167, 0x10000, v163
    v_and_b32 v5, 15, v1
    v_lshrrev_b32 v5, 2, v5
    v_and_b32 v6, 3, v1
    v_lshlrev_b32 v7, 3, v3
    v_add_u32 v7, v7, v5
    v_lshlrev_b32 v7, 8, v7
    v_xor_b32 v8, s30, v5
    v_lshlrev_b32 v8, 6, v8
    v_add_u32 v7, v7, v8
    v_lshrrev_b32 v8, 4, v1
    v_and_b32 v8, 1, v8
    v_lshlrev_b32 v8, 5, v8
    v_add_u32 v7, v7, v8
    v_lshlrev_b32 v6, 3, v6
    v_add_u32 v7, v7, v6
    s_lshl_b32 s33, s31, 12
    s_add_u32 s33, s33, 0x4000
    s_xor_b32 s34, s33, 0
    v_add_u32 v168, s34, v7
    v_add_u32 v172, 0x10000, v168
    s_xor_b32 s34, s33, 4096
    v_add_u32 v169, s34, v7
    v_add_u32 v173, 0x10000, v169
    s_xor_b32 s34, s33, 8192
    v_add_u32 v170, s34, v7
    v_add_u32 v174, 0x10000, v170
    s_xor_b32 s34, s33, 12288
    v_add_u32 v171, s34, v7
    v_add_u32 v175, 0x10000, v171
    v_mov_b32 v240, 0x3f800000
    v_mov_b32 v241, 0x3f800000
    v_mov_b32 v242, 0x3fb8aa3b
    v_mov_b32 v243, 0x3fb8aa3b
    v_mov_b32 v244, 0x358637bd
    v_mov_b32 v245, 0x358637bd
    v_mov_b32 v246, 0x3d372713
    v_mov_b32 v247, 0x3d372713
    v_mov_b32 v248, 0xc0135761
    v_mov_b32 v249, 0xc0135761
    v_mov_b32 v200, 0x3f803f80
    v_mov_b32 v201, 0x3f803f80
    s_waitcnt vmcnt(4)
    s_barrier
    ds_read_b128 v[64:67], v160 offset:0
    ds_read_b64_tr_b16 v[72:73], v168 offset:0
    ds_read_b64_tr_b16 v[74:75], v168 offset:1024
    ds_read_b128 v[68:71], v160 offset:4096
    ds_read_b128 v[76:79], v161 offset:0
    ds_read_b64_tr_b16 v[84:85], v169 offset:0
    ds_read_b64_tr_b16 v[86:87], v169 offset:1024
    ds_read_b128 v[80:83], v161 offset:4096
    ds_read_b128 v[88:91], v162 offset:0
    ds_read_b64_tr_b16 v[96:97], v170 offset:0
    ds_read_b64_tr_b16 v[98:99], v170 offset:1024
    ds_read_b128 v[92:95], v162 offset:4096
    ds_read_b128 v[100:103], v163 offset:0
    ds_read_b64_tr_b16 v[108:109], v171 offset:0
    ds_read_b64_tr_b16 v[110:111], v171 offset:1024
    ds_read_b128 v[104:107], v163 offset:4096
    s_waitcnt lgkmcnt(0)
    s_waitcnt vmcnt(0)
    s_barrier
    v_mfma_f32_32x32x16_bf16 v[32:47], v[64:67], v[72:75], 0
    ds_read_b128 v[112:115], v160 offset:32768
    ds_read_b64_tr_b16 v[120:121], v168 offset:32768
    s_add_u32 s48, s32, 2
    s_sub_u32 s49, s48, 10
    s_cmp_ge_u32 s48, 10
    s_cselect_b32 s48, s49, s48
    s_add_u32 m0, s35, 65536
    s_lshl_b32 s36, s48, 7
    buffer_load_dwordx4 v176, s[12:15], s36 offen lds
    buffer_load_dwordx4 v177, s[12:15], s36 offen offset:1024 lds
    v_mfma_f32_4x4x4_16b_bf16 v[196:199], v[72:73], v[200:201], 0
    v_mfma_f32_4x4x4_16b_bf16 v[180:183], v[64:65], v[200:201], 0
    v_mfma_f32_32x32x16_bf16 v[48:63], v[68:71], v[72:75], 0
    ds_read_b64_tr_b16 v[122:123], v168 offset:33792
    ds_read_b128 v[116:119], v160 offset:36864
    v_mfma_f32_4x4x4_16b_bf16 v[184:187], v[64:65], v[64:65], 0
    v_mfma_f32_4x4x4_16b_bf16 v[188:191], v[68:69], v[200:201], 0
    v_mfma_f32_32x32x16_bf16 v[32:47], v[76:79], v[84:87], v[32:47]
    ds_read_b128 v[124:127], v161 offset:32768
    ds_read_b64_tr_b16 v[132:133], v169 offset:32768
    s_add_u32 m0, s35, 81920
    s_mul_i32 s37, s38, s48
    buffer_load_dwordx4 v178, s[16:19], s37 offen lds
    buffer_load_dwordx4 v179, s[16:19], s37 offen offset:1024 lds
    v_mfma_f32_4x4x4_16b_bf16 v[192:195], v[68:69], v[68:69], 0
    v_mfma_f32_4x4x4_16b_bf16 v[196:199], v[96:97], v[200:201], v[196:199]
    v_mfma_f32_32x32x16_bf16 v[48:63], v[80:83], v[84:87], v[48:63]
    ds_read_b64_tr_b16 v[134:135], v169 offset:33792
    ds_read_b128 v[128:131], v161 offset:36864
    v_mfma_f32_4x4x4_16b_bf16 v[196:199], v[74:75], v[200:201], v[196:199]
    v_mfma_f32_4x4x4_16b_bf16 v[180:183], v[66:67], v[200:201], v[180:183]
    v_mfma_f32_32x32x16_bf16 v[32:47], v[88:91], v[96:99], v[32:47]
    ds_read_b128 v[136:139], v162 offset:32768
    ds_read_b64_tr_b16 v[144:145], v170 offset:32768
    s_add_u32 s48, s32, 3
    s_sub_u32 s49, s48, 10
    s_cmp_ge_u32 s48, 10
    s_cselect_b32 s48, s49, s48
    s_add_u32 m0, s35, 98304
    s_lshl_b32 s36, s48, 7
    buffer_load_dwordx4 v176, s[12:15], s36 offen lds
    buffer_load_dwordx4 v177, s[12:15], s36 offen offset:1024 lds
    v_mfma_f32_4x4x4_16b_bf16 v[184:187], v[66:67], v[66:67], v[184:187]
    v_mfma_f32_4x4x4_16b_bf16 v[188:191], v[70:71], v[200:201], v[188:191]
    v_mfma_f32_32x32x16_bf16 v[48:63], v[92:95], v[96:99], v[48:63]
    ds_read_b64_tr_b16 v[146:147], v170 offset:33792
    ds_read_b128 v[140:143], v162 offset:36864
    v_mfma_f32_4x4x4_16b_bf16 v[192:195], v[70:71], v[70:71], v[192:195]
    v_mfma_f32_4x4x4_16b_bf16 v[196:199], v[98:99], v[200:201], v[196:199]
    v_mfma_f32_32x32x16_bf16 v[32:47], v[100:103], v[108:111], v[32:47]
    ds_read_b128 v[148:151], v163 offset:32768
    ds_read_b64_tr_b16 v[156:157], v171 offset:32768
    s_add_u32 m0, s35, 114688
    s_mul_i32 s37, s38, s48
    buffer_load_dwordx4 v178, s[16:19], s37 offen lds
    buffer_load_dwordx4 v179, s[16:19], s37 offen offset:1024 lds
    v_mfma_f32_32x32x16_bf16 v[48:63], v[104:107], v[108:111], v[48:63]
    ds_read_b64_tr_b16 v[158:159], v171 offset:33792
    ds_read_b128 v[152:155], v163 offset:36864
    s_waitcnt lgkmcnt(0)
    s_waitcnt vmcnt(4)
    s_barrier
    v_mfma_f32_32x32x16_bf16 v[32:47], v[112:115], v[120:123], v[32:47]
    ds_read_b128 v[64:67], v164 offset:0
    ds_read_b64_tr_b16 v[72:73], v172 offset:0
    s_add_u32 s48, s32, 4
    s_sub_u32 s49, s48, 10
    s_cmp_ge_u32 s48, 10
    s_cselect_b32 s48, s49, s48
    s_add_u32 m0, s35, 0
    s_lshl_b32 s36, s48, 7
    buffer_load_dwordx4 v176, s[12:15], s36 offen lds
    buffer_load_dwordx4 v177, s[12:15], s36 offen offset:1024 lds
    v_mfma_f32_4x4x4_16b_bf16 v[196:199], v[120:121], v[200:201], v[196:199]
    v_mfma_f32_4x4x4_16b_bf16 v[180:183], v[112:113], v[200:201], v[180:183]
    v_mfma_f32_32x32x16_bf16 v[48:63], v[116:119], v[120:123], v[48:63]
    ds_read_b64_tr_b16 v[74:75], v172 offset:1024
    ds_read_b128 v[68:71], v164 offset:4096
    v_mfma_f32_4x4x4_16b_bf16 v[184:187], v[112:113], v[112:113], v[184:187]
    v_mfma_f32_4x4x4_16b_bf16 v[188:191], v[116:117], v[200:201], v[188:191]
    v_mfma_f32_32x32x16_bf16 v[32:47], v[124:127], v[132:135], v[32:47]
    ds_read_b128 v[76:79], v165 offset:0
    ds_read_b64_tr_b16 v[84:85], v173 offset:0
    s_add_u32 m0, s35, 16384
    s_mul_i32 s37, s38, s48
    buffer_load_dwordx4 v178, s[16:19], s37 offen lds
    buffer_load_dwordx4 v179, s[16:19], s37 offen offset:1024 lds
    v_mfma_f32_4x4x4_16b_bf16 v[192:195], v[116:117], v[116:117], v[192:195]
    v_mfma_f32_4x4x4_16b_bf16 v[196:199], v[144:145], v[200:201], v[196:199]
    v_mfma_f32_32x32x16_bf16 v[48:63], v[128:131], v[132:135], v[48:63]
    ds_read_b64_tr_b16 v[86:87], v173 offset:1024
    ds_read_b128 v[80:83], v165 offset:4096
    v_mfma_f32_4x4x4_16b_bf16 v[196:199], v[122:123], v[200:201], v[196:199]
    v_mfma_f32_4x4x4_16b_bf16 v[180:183], v[114:115], v[200:201], v[180:183]
    v_mfma_f32_32x32x16_bf16 v[32:47], v[136:139], v[144:147], v[32:47]
    ds_read_b128 v[88:91], v166 offset:0
    ds_read_b64_tr_b16 v[96:97], v174 offset:0
    v_mfma_f32_4x4x4_16b_bf16 v[184:187], v[114:115], v[114:115], v[184:187]
    v_mfma_f32_4x4x4_16b_bf16 v[188:191], v[118:119], v[200:201], v[188:191]
    v_mfma_f32_32x32x16_bf16 v[48:63], v[140:143], v[144:147], v[48:63]
    ds_read_b64_tr_b16 v[98:99], v174 offset:1024
    ds_read_b128 v[92:95], v166 offset:4096
    v_mfma_f32_4x4x4_16b_bf16 v[192:195], v[118:119], v[118:119], v[192:195]
    v_mfma_f32_4x4x4_16b_bf16 v[196:199], v[146:147], v[200:201], v[196:199]
    v_mfma_f32_32x32x16_bf16 v[32:47], v[148:151], v[156:159], v[32:47]
    ds_read_b128 v[100:103], v167 offset:0
    ds_read_b64_tr_b16 v[108:109], v175 offset:0
    v_mfma_f32_32x32x16_bf16 v[48:63], v[152:155], v[156:159], v[48:63]
    ds_read_b64_tr_b16 v[110:111], v175 offset:1024
    ds_read_b128 v[104:107], v167 offset:4096
    s_waitcnt lgkmcnt(0)
    s_waitcnt vmcnt(4)
    s_barrier
    v_mfma_f32_32x32x16_bf16 v[32:47], v[64:67], v[72:75], v[32:47]
    ds_read_b128 v[112:115], v164 offset:32768
    ds_read_b64_tr_b16 v[120:121], v172 offset:32768
    s_add_u32 s48, s32, 5
    s_sub_u32 s49, s48, 10
    s_cmp_ge_u32 s48, 10
    s_cselect_b32 s48, s49, s48
    s_add_u32 m0, s35, 32768
    s_lshl_b32 s36, s48, 7
    buffer_load_dwordx4 v176, s[12:15], s36 offen lds
    buffer_load_dwordx4 v177, s[12:15], s36 offen offset:1024 lds
    v_mfma_f32_4x4x4_16b_bf16 v[196:199], v[72:73], v[200:201], v[196:199]
    v_mfma_f32_4x4x4_16b_bf16 v[180:183], v[64:65], v[200:201], v[180:183]
    v_mfma_f32_32x32x16_bf16 v[48:63], v[68:71], v[72:75], v[48:63]
    ds_read_b64_tr_b16 v[122:123], v172 offset:33792
    ds_read_b128 v[116:119], v164 offset:36864
    v_mfma_f32_4x4x4_16b_bf16 v[184:187], v[64:65], v[64:65], v[184:187]
    v_mfma_f32_4x4x4_16b_bf16 v[188:191], v[68:69], v[200:201], v[188:191]
    v_mfma_f32_32x32x16_bf16 v[32:47], v[76:79], v[84:87], v[32:47]
    ds_read_b128 v[124:127], v165 offset:32768
    ds_read_b64_tr_b16 v[132:133], v173 offset:32768
    s_add_u32 m0, s35, 49152
    s_mul_i32 s37, s38, s48
    buffer_load_dwordx4 v178, s[16:19], s37 offen lds
    buffer_load_dwordx4 v179, s[16:19], s37 offen offset:1024 lds
    v_mfma_f32_4x4x4_16b_bf16 v[192:195], v[68:69], v[68:69], v[192:195]
    v_mfma_f32_4x4x4_16b_bf16 v[196:199], v[96:97], v[200:201], v[196:199]
    v_mfma_f32_32x32x16_bf16 v[48:63], v[80:83], v[84:87], v[48:63]
    ds_read_b64_tr_b16 v[134:135], v173 offset:33792
    ds_read_b128 v[128:131], v165 offset:36864
    v_mfma_f32_4x4x4_16b_bf16 v[196:199], v[74:75], v[200:201], v[196:199]
    v_mfma_f32_4x4x4_16b_bf16 v[180:183], v[66:67], v[200:201], v[180:183]
    v_mfma_f32_32x32x16_bf16 v[32:47], v[88:91], v[96:99], v[32:47]
    ds_read_b128 v[136:139], v166 offset:32768
    ds_read_b64_tr_b16 v[144:145], v174 offset:32768
    v_mfma_f32_4x4x4_16b_bf16 v[184:187], v[66:67], v[66:67], v[184:187]
    v_mfma_f32_4x4x4_16b_bf16 v[188:191], v[70:71], v[200:201], v[188:191]
    v_mfma_f32_32x32x16_bf16 v[48:63], v[92:95], v[96:99], v[48:63]
    ds_read_b64_tr_b16 v[146:147], v174 offset:33792
    ds_read_b128 v[140:143], v166 offset:36864
    v_mfma_f32_4x4x4_16b_bf16 v[192:195], v[70:71], v[70:71], v[192:195]
    v_mfma_f32_4x4x4_16b_bf16 v[196:199], v[98:99], v[200:201], v[196:199]
    v_mfma_f32_32x32x16_bf16 v[32:47], v[100:103], v[108:111], v[32:47]
    ds_read_b128 v[148:151], v167 offset:32768
    ds_read_b64_tr_b16 v[156:157], v175 offset:32768
    v_mfma_f32_32x32x16_bf16 v[48:63], v[104:107], v[108:111], v[48:63]
    ds_read_b64_tr_b16 v[158:159], v175 offset:33792
    ds_read_b128 v[152:155], v167 offset:36864
    s_waitcnt lgkmcnt(0)
    s_waitcnt vmcnt(4)
    s_barrier
    v_mfma_f32_32x32x16_bf16 v[32:47], v[112:115], v[120:123], v[32:47]
    ds_read_b128 v[64:67], v160 offset:0
    ds_read_b64_tr_b16 v[72:73], v168 offset:0
    s_add_u32 s48, s32, 6
    s_sub_u32 s49, s48, 10
    s_cmp_ge_u32 s48, 10
    s_cselect_b32 s48, s49, s48
    s_add_u32 m0, s35, 65536
    s_lshl_b32 s36, s48, 7
    buffer_load_dwordx4 v176, s[12:15], s36 offen lds
    buffer_load_dwordx4 v177, s[12:15], s36 offen offset:1024 lds
    v_mfma_f32_4x4x4_16b_bf16 v[196:199], v[120:121], v[200:201], v[196:199]
    v_mfma_f32_4x4x4_16b_bf16 v[180:183], v[112:113], v[200:201], v[180:183]
    v_mfma_f32_32x32x16_bf16 v[48:63], v[116:119], v[120:123], v[48:63]
    ds_read_b64_tr_b16 v[74:75], v168 offset:1024
    ds_read_b128 v[68:71], v160 offset:4096
    v_mfma_f32_4x4x4_16b_bf16 v[184:187], v[112:113], v[112:113], v[184:187]
    v_mfma_f32_4x4x4_16b_bf16 v[188:191], v[116:117], v[200:201], v[188:191]
    v_mfma_f32_32x32x16_bf16 v[32:47], v[124:127], v[132:135], v[32:47]
    ds_read_b128 v[76:79], v161 offset:0
    ds_read_b64_tr_b16 v[84:85], v169 offset:0
    s_add_u32 m0, s35, 81920
    s_mul_i32 s37, s38, s48
    buffer_load_dwordx4 v178, s[16:19], s37 offen lds
    buffer_load_dwordx4 v179, s[16:19], s37 offen offset:1024 lds
    v_mfma_f32_4x4x4_16b_bf16 v[192:195], v[116:117], v[116:117], v[192:195]
    v_mfma_f32_4x4x4_16b_bf16 v[196:199], v[144:145], v[200:201], v[196:199]
    v_mfma_f32_32x32x16_bf16 v[48:63], v[128:131], v[132:135], v[48:63]
    ds_read_b64_tr_b16 v[86:87], v169 offset:1024
    ds_read_b128 v[80:83], v161 offset:4096
    v_mfma_f32_4x4x4_16b_bf16 v[196:199], v[122:123], v[200:201], v[196:199]
    v_mfma_f32_4x4x4_16b_bf16 v[180:183], v[114:115], v[200:201], v[180:183]
    v_mfma_f32_32x32x16_bf16 v[32:47], v[136:139], v[144:147], v[32:47]
    ds_read_b128 v[88:91], v162 offset:0
    ds_read_b64_tr_b16 v[96:97], v170 offset:0
    v_mfma_f32_4x4x4_16b_bf16 v[184:187], v[114:115], v[114:115], v[184:187]
    v_mfma_f32_4x4x4_16b_bf16 v[188:191], v[118:119], v[200:201], v[188:191]
    v_mfma_f32_32x32x16_bf16 v[48:63], v[140:143], v[144:147], v[48:63]
    ds_read_b64_tr_b16 v[98:99], v170 offset:1024
    ds_read_b128 v[92:95], v162 offset:4096
    v_mfma_f32_4x4x4_16b_bf16 v[192:195], v[118:119], v[118:119], v[192:195]
    v_mfma_f32_4x4x4_16b_bf16 v[196:199], v[146:147], v[200:201], v[196:199]
    v_mfma_f32_32x32x16_bf16 v[32:47], v[148:151], v[156:159], v[32:47]
    ds_read_b128 v[100:103], v163 offset:0
    ds_read_b64_tr_b16 v[108:109], v171 offset:0
    v_mfma_f32_32x32x16_bf16 v[48:63], v[152:155], v[156:159], v[48:63]
    ds_read_b64_tr_b16 v[110:111], v171 offset:1024
    ds_read_b128 v[104:107], v163 offset:4096
    s_waitcnt lgkmcnt(0)
    s_waitcnt vmcnt(4)
    s_barrier
    v_mfma_f32_32x32x16_bf16 v[32:47], v[64:67], v[72:75], v[32:47]
    ds_read_b128 v[112:115], v160 offset:32768
    ds_read_b64_tr_b16 v[120:121], v168 offset:32768
    s_add_u32 s48, s32, 7
    s_sub_u32 s49, s48, 10
    s_cmp_ge_u32 s48, 10
    s_cselect_b32 s48, s49, s48
    s_add_u32 m0, s35, 98304
    s_lshl_b32 s36, s48, 7
    buffer_load_dwordx4 v176, s[12:15], s36 offen lds
    buffer_load_dwordx4 v177, s[12:15], s36 offen offset:1024 lds
    v_mfma_f32_4x4x4_16b_bf16 v[196:199], v[72:73], v[200:201], v[196:199]
    v_mfma_f32_4x4x4_16b_bf16 v[180:183], v[64:65], v[200:201], v[180:183]
    v_mfma_f32_32x32x16_bf16 v[48:63], v[68:71], v[72:75], v[48:63]
    ds_read_b64_tr_b16 v[122:123], v168 offset:33792
    ds_read_b128 v[116:119], v160 offset:36864
    v_mfma_f32_4x4x4_16b_bf16 v[184:187], v[64:65], v[64:65], v[184:187]
    v_mfma_f32_4x4x4_16b_bf16 v[188:191], v[68:69], v[200:201], v[188:191]
    v_mfma_f32_32x32x16_bf16 v[32:47], v[76:79], v[84:87], v[32:47]
    ds_read_b128 v[124:127], v161 offset:32768
    ds_read_b64_tr_b16 v[132:133], v169 offset:32768
    s_add_u32 m0, s35, 114688
    s_mul_i32 s37, s38, s48
    buffer_load_dwordx4 v178, s[16:19], s37 offen lds
    buffer_load_dwordx4 v179, s[16:19], s37 offen offset:1024 lds
    v_mfma_f32_4x4x4_16b_bf16 v[192:195], v[68:69], v[68:69], v[192:195]
    v_mfma_f32_4x4x4_16b_bf16 v[196:199], v[96:97], v[200:201], v[196:199]
    v_mfma_f32_32x32x16_bf16 v[48:63], v[80:83], v[84:87], v[48:63]
    ds_read_b64_tr_b16 v[134:135], v169 offset:33792
    ds_read_b128 v[128:131], v161 offset:36864
    v_mfma_f32_4x4x4_16b_bf16 v[196:199], v[74:75], v[200:201], v[196:199]
    v_mfma_f32_4x4x4_16b_bf16 v[180:183], v[66:67], v[200:201], v[180:183]
    v_mfma_f32_32x32x16_bf16 v[32:47], v[88:91], v[96:99], v[32:47]
    ds_read_b128 v[136:139], v162 offset:32768
    ds_read_b64_tr_b16 v[144:145], v170 offset:32768
    v_mfma_f32_4x4x4_16b_bf16 v[184:187], v[66:67], v[66:67], v[184:187]
    v_mfma_f32_4x4x4_16b_bf16 v[188:191], v[70:71], v[200:201], v[188:191]
    v_mfma_f32_32x32x16_bf16 v[48:63], v[92:95], v[96:99], v[48:63]
    ds_read_b64_tr_b16 v[146:147], v170 offset:33792
    ds_read_b128 v[140:143], v162 offset:36864
    v_mfma_f32_4x4x4_16b_bf16 v[192:195], v[70:71], v[70:71], v[192:195]
    v_mfma_f32_4x4x4_16b_bf16 v[196:199], v[98:99], v[200:201], v[196:199]
    v_mfma_f32_32x32x16_bf16 v[32:47], v[100:103], v[108:111], v[32:47]
    ds_read_b128 v[148:151], v163 offset:32768
    ds_read_b64_tr_b16 v[156:157], v171 offset:32768
    v_mfma_f32_32x32x16_bf16 v[48:63], v[104:107], v[108:111], v[48:63]
    ds_read_b64_tr_b16 v[158:159], v171 offset:33792
    ds_read_b128 v[152:155], v163 offset:36864
    s_waitcnt lgkmcnt(0)
    s_waitcnt vmcnt(4)
    s_barrier
    v_mfma_f32_32x32x16_bf16 v[32:47], v[112:115], v[120:123], v[32:47]
    ds_read_b128 v[64:67], v164 offset:0
    ds_read_b64_tr_b16 v[72:73], v172 offset:0
    s_add_u32 s48, s32, 8
    s_sub_u32 s49, s48, 10
    s_cmp_ge_u32 s48, 10
    s_cselect_b32 s48, s49, s48
    s_add_u32 m0, s35, 0
    s_lshl_b32 s36, s48, 7
    buffer_load_dwordx4 v176, s[12:15], s36 offen lds
    buffer_load_dwordx4 v177, s[12:15], s36 offen offset:1024 lds
    v_mfma_f32_4x4x4_16b_bf16 v[196:199], v[120:121], v[200:201], v[196:199]
    v_mfma_f32_4x4x4_16b_bf16 v[180:183], v[112:113], v[200:201], v[180:183]
    v_mfma_f32_32x32x16_bf16 v[48:63], v[116:119], v[120:123], v[48:63]
    ds_read_b64_tr_b16 v[74:75], v172 offset:1024
    ds_read_b128 v[68:71], v164 offset:4096
    v_mfma_f32_4x4x4_16b_bf16 v[184:187], v[112:113], v[112:113], v[184:187]
    v_mfma_f32_4x4x4_16b_bf16 v[188:191], v[116:117], v[200:201], v[188:191]
    v_mfma_f32_32x32x16_bf16 v[32:47], v[124:127], v[132:135], v[32:47]
    ds_read_b128 v[76:79], v165 offset:0
    ds_read_b64_tr_b16 v[84:85], v173 offset:0
    s_add_u32 m0, s35, 16384
    s_mul_i32 s37, s38, s48
    buffer_load_dwordx4 v178, s[16:19], s37 offen lds
    buffer_load_dwordx4 v179, s[16:19], s37 offen offset:1024 lds
    v_mfma_f32_4x4x4_16b_bf16 v[192:195], v[116:117], v[116:117], v[192:195]
    v_mfma_f32_4x4x4_16b_bf16 v[196:199], v[144:145], v[200:201], v[196:199]
    v_mfma_f32_32x32x16_bf16 v[48:63], v[128:131], v[132:135], v[48:63]
    ds_read_b64_tr_b16 v[86:87], v173 offset:1024
    ds_read_b128 v[80:83], v165 offset:4096
    v_mfma_f32_4x4x4_16b_bf16 v[196:199], v[122:123], v[200:201], v[196:199]
    v_mfma_f32_4x4x4_16b_bf16 v[180:183], v[114:115], v[200:201], v[180:183]
    v_mfma_f32_32x32x16_bf16 v[32:47], v[136:139], v[144:147], v[32:47]
    ds_read_b128 v[88:91], v166 offset:0
    ds_read_b64_tr_b16 v[96:97], v174 offset:0
    v_mfma_f32_4x4x4_16b_bf16 v[184:187], v[114:115], v[114:115], v[184:187]
    v_mfma_f32_4x4x4_16b_bf16 v[188:191], v[118:119], v[200:201], v[188:191]
    v_mfma_f32_32x32x16_bf16 v[48:63], v[140:143], v[144:147], v[48:63]
    ds_read_b64_tr_b16 v[98:99], v174 offset:1024
    ds_read_b128 v[92:95], v166 offset:4096
    v_mfma_f32_4x4x4_16b_bf16 v[192:195], v[118:119], v[118:119], v[192:195]
    v_mfma_f32_4x4x4_16b_bf16 v[196:199], v[146:147], v[200:201], v[196:199]
    v_mfma_f32_32x32x16_bf16 v[32:47], v[148:151], v[156:159], v[32:47]
    ds_read_b128 v[100:103], v167 offset:0
    ds_read_b64_tr_b16 v[108:109], v175 offset:0
    v_mfma_f32_32x32x16_bf16 v[48:63], v[152:155], v[156:159], v[48:63]
    ds_read_b64_tr_b16 v[110:111], v175 offset:1024
    ds_read_b128 v[104:107], v167 offset:4096
    s_waitcnt lgkmcnt(0)
    s_waitcnt vmcnt(4)
    s_barrier
    v_mfma_f32_32x32x16_bf16 v[32:47], v[64:67], v[72:75], v[32:47]
    ds_read_b128 v[112:115], v164 offset:32768
    ds_read_b64_tr_b16 v[120:121], v172 offset:32768
    s_add_u32 s48, s32, 9
    s_sub_u32 s49, s48, 10
    s_cmp_ge_u32 s48, 10
    s_cselect_b32 s48, s49, s48
    s_add_u32 m0, s35, 32768
    s_lshl_b32 s36, s48, 7
    buffer_load_dwordx4 v176, s[12:15], s36 offen lds
    buffer_load_dwordx4 v177, s[12:15], s36 offen offset:1024 lds
    v_mfma_f32_4x4x4_16b_bf16 v[196:199], v[72:73], v[200:201], v[196:199]
    v_mfma_f32_4x4x4_16b_bf16 v[180:183], v[64:65], v[200:201], v[180:183]
    v_mfma_f32_32x32x16_bf16 v[48:63], v[68:71], v[72:75], v[48:63]
    ds_read_b64_tr_b16 v[122:123], v172 offset:33792
    ds_read_b128 v[116:119], v164 offset:36864
    v_mfma_f32_4x4x4_16b_bf16 v[184:187], v[64:65], v[64:65], v[184:187]
    v_mfma_f32_4x4x4_16b_bf16 v[188:191], v[68:69], v[200:201], v[188:191]
    v_mfma_f32_32x32x16_bf16 v[32:47], v[76:79], v[84:87], v[32:47]
    ds_read_b128 v[124:127], v165 offset:32768
    ds_read_b64_tr_b16 v[132:133], v173 offset:32768
    s_add_u32 m0, s35, 49152
    s_mul_i32 s37, s38, s48
    buffer_load_dwordx4 v178, s[16:19], s37 offen lds
    buffer_load_dwordx4 v179, s[16:19], s37 offen offset:1024 lds
    v_mfma_f32_4x4x4_16b_bf16 v[192:195], v[68:69], v[68:69], v[192:195]
    v_mfma_f32_4x4x4_16b_bf16 v[196:199], v[96:97], v[200:201], v[196:199]
    v_mfma_f32_32x32x16_bf16 v[48:63], v[80:83], v[84:87], v[48:63]
    ds_read_b64_tr_b16 v[134:135], v173 offset:33792
    ds_read_b128 v[128:131], v165 offset:36864
    v_mfma_f32_4x4x4_16b_bf16 v[196:199], v[74:75], v[200:201], v[196:199]
    v_mfma_f32_4x4x4_16b_bf16 v[180:183], v[66:67], v[200:201], v[180:183]
    v_mfma_f32_32x32x16_bf16 v[32:47], v[88:91], v[96:99], v[32:47]
    ds_read_b128 v[136:139], v166 offset:32768
    ds_read_b64_tr_b16 v[144:145], v174 offset:32768
    v_mfma_f32_4x4x4_16b_bf16 v[184:187], v[66:67], v[66:67], v[184:187]
    v_mfma_f32_4x4x4_16b_bf16 v[188:191], v[70:71], v[200:201], v[188:191]
    v_mfma_f32_32x32x16_bf16 v[48:63], v[92:95], v[96:99], v[48:63]
    ds_read_b64_tr_b16 v[146:147], v174 offset:33792
    ds_read_b128 v[140:143], v166 offset:36864
    s_load_dwordx2 s[56:57], s[0:1], 40
    v_mfma_f32_4x4x4_16b_bf16 v[192:195], v[70:71], v[70:71], v[192:195]
    v_mfma_f32_4x4x4_16b_bf16 v[196:199], v[98:99], v[200:201], v[196:199]
    v_mfma_f32_32x32x16_bf16 v[32:47], v[100:103], v[108:111], v[32:47]
    ds_read_b128 v[148:151], v167 offset:32768
    ds_read_b64_tr_b16 v[156:157], v175 offset:32768
    v_mfma_f32_32x32x16_bf16 v[48:63], v[104:107], v[108:111], v[48:63]
    ds_read_b64_tr_b16 v[158:159], v175 offset:33792
    ds_read_b128 v[152:155], v167 offset:36864
    s_waitcnt lgkmcnt(0)
    s_waitcnt vmcnt(4)
    s_barrier
    v_mfma_f32_32x32x16_bf16 v[32:47], v[112:115], v[120:123], v[32:47]
    ds_read_b128 v[64:67], v160 offset:0
    ds_read_b64_tr_b16 v[72:73], v168 offset:0
    v_mfma_f32_4x4x4_16b_bf16 v[196:199], v[120:121], v[200:201], v[196:199]
    v_mfma_f32_4x4x4_16b_bf16 v[180:183], v[112:113], v[200:201], v[180:183]
    v_mfma_f32_32x32x16_bf16 v[48:63], v[116:119], v[120:123], v[48:63]
    ds_read_b64_tr_b16 v[74:75], v168 offset:1024
    ds_read_b128 v[68:71], v160 offset:4096
    v_mfma_f32_4x4x4_16b_bf16 v[184:187], v[112:113], v[112:113], v[184:187]
    v_mfma_f32_4x4x4_16b_bf16 v[188:191], v[116:117], v[200:201], v[188:191]
    v_mfma_f32_32x32x16_bf16 v[32:47], v[124:127], v[132:135], v[32:47]
    ds_read_b128 v[76:79], v161 offset:0
    ds_read_b64_tr_b16 v[84:85], v169 offset:0
    v_mfma_f32_4x4x4_16b_bf16 v[192:195], v[116:117], v[116:117], v[192:195]
    v_mfma_f32_4x4x4_16b_bf16 v[196:199], v[144:145], v[200:201], v[196:199]
    v_mfma_f32_32x32x16_bf16 v[48:63], v[128:131], v[132:135], v[48:63]
    ds_read_b64_tr_b16 v[86:87], v169 offset:1024
    ds_read_b128 v[80:83], v161 offset:4096
    v_mfma_f32_4x4x4_16b_bf16 v[196:199], v[122:123], v[200:201], v[196:199]
    v_mfma_f32_4x4x4_16b_bf16 v[180:183], v[114:115], v[200:201], v[180:183]
    v_mfma_f32_32x32x16_bf16 v[32:47], v[136:139], v[144:147], v[32:47]
    ds_read_b128 v[88:91], v162 offset:0
    ds_read_b64_tr_b16 v[96:97], v170 offset:0
    v_mfma_f32_4x4x4_16b_bf16 v[184:187], v[114:115], v[114:115], v[184:187]
    v_mfma_f32_4x4x4_16b_bf16 v[188:191], v[118:119], v[200:201], v[188:191]
    v_mfma_f32_32x32x16_bf16 v[48:63], v[140:143], v[144:147], v[48:63]
    ds_read_b64_tr_b16 v[98:99], v170 offset:1024
    ds_read_b128 v[92:95], v162 offset:4096
    s_lshl_b32 s42, s2, 3
    s_add_u32 s42, s42, s28
    s_lshl_b32 s42, s42, 12
    v_and_b32 v5, 31, v1
    v_lshlrev_b32 v5, 7, v5
    s_and_b32 s57, s57, 0xffff
    s_mov_b32 s58, 8388608
    s_mov_b32 s59, 0x00020000
    buffer_load_dword v8, v5, s[56:59], s42 offen
    s_lshr_b32 s42, s2, 3
    s_mul_i32 s42, s42, 20
    s_and_b32 s43, s28, 3
    s_lshl_b32 s43, s43, 6
    v_add_u32 v4, s43, v1
    v_lshrrev_b32 v5, 4, v4
    v_and_b32 v6, 15, v4
    s_cmp_lt_u32 s28, 4
    s_cselect_b32 s44, s6, s8
    s_cselect_b32 s45, s7, s9
    s_movk_i32 s43, 3840
    s_mov_b32 s46, 2457600
    s_cselect_b32 s43, s43, 3072
    s_cselect_b32 s46, s46, 1966080
    s_and_b32 s45, s45, 0xffff
    s_mov_b32 s47, 0x00020000
    v_add_u32 v5, s42, v5
    v_mul_lo_u32 v5, v5, s43
    v_min_u32 v6, 11, v6
    v_lshl_add_u32 v5, v6, 7, v5
    s_lshl_b32 s43, s43, 4
    buffer_load_dword v8, v5, s[44:47], 0 offen
    buffer_load_dword v8, v5, s[44:47], s43 offen
    v_mfma_f32_4x4x4_16b_bf16 v[192:195], v[118:119], v[118:119], v[192:195]
    v_mfma_f32_4x4x4_16b_bf16 v[196:199], v[146:147], v[200:201], v[196:199]
    v_mfma_f32_32x32x16_bf16 v[32:47], v[148:151], v[156:159], v[32:47]
    ds_read_b128 v[100:103], v163 offset:0
    ds_read_b64_tr_b16 v[108:109], v171 offset:0
    v_mfma_f32_32x32x16_bf16 v[48:63], v[152:155], v[156:159], v[48:63]
    ds_read_b64_tr_b16 v[110:111], v171 offset:1024
    ds_read_b128 v[104:107], v163 offset:4096
    s_waitcnt lgkmcnt(0)
    s_waitcnt vmcnt(3)
    s_barrier
    v_mfma_f32_32x32x16_bf16 v[32:47], v[64:67], v[72:75], v[32:47]
    ds_read_b128 v[112:115], v160 offset:32768
    ds_read_b64_tr_b16 v[120:121], v168 offset:32768
    v_mfma_f32_4x4x4_16b_bf16 v[196:199], v[72:73], v[200:201], v[196:199]
    v_mfma_f32_4x4x4_16b_bf16 v[180:183], v[64:65], v[200:201], v[180:183]
    v_mfma_f32_32x32x16_bf16 v[48:63], v[68:71], v[72:75], v[48:63]
    ds_read_b64_tr_b16 v[122:123], v168 offset:33792
    ds_read_b128 v[116:119], v160 offset:36864
    v_mfma_f32_4x4x4_16b_bf16 v[184:187], v[64:65], v[64:65], v[184:187]
    v_mfma_f32_4x4x4_16b_bf16 v[188:191], v[68:69], v[200:201], v[188:191]
    v_mfma_f32_32x32x16_bf16 v[32:47], v[76:79], v[84:87], v[32:47]
    ds_read_b128 v[124:127], v161 offset:32768
    ds_read_b64_tr_b16 v[132:133], v169 offset:32768
    v_mfma_f32_4x4x4_16b_bf16 v[192:195], v[68:69], v[68:69], v[192:195]
    v_mfma_f32_4x4x4_16b_bf16 v[196:199], v[96:97], v[200:201], v[196:199]
    v_mfma_f32_32x32x16_bf16 v[48:63], v[80:83], v[84:87], v[48:63]
    ds_read_b64_tr_b16 v[134:135], v169 offset:33792
    ds_read_b128 v[128:131], v161 offset:36864
    v_mfma_f32_4x4x4_16b_bf16 v[196:199], v[74:75], v[200:201], v[196:199]
    v_mfma_f32_4x4x4_16b_bf16 v[180:183], v[66:67], v[200:201], v[180:183]
    v_mfma_f32_32x32x16_bf16 v[32:47], v[88:91], v[96:99], v[32:47]
    ds_read_b128 v[136:139], v162 offset:32768
    ds_read_b64_tr_b16 v[144:145], v170 offset:32768
    v_mfma_f32_4x4x4_16b_bf16 v[184:187], v[66:67], v[66:67], v[184:187]
    v_mfma_f32_4x4x4_16b_bf16 v[188:191], v[70:71], v[200:201], v[188:191]
    v_mfma_f32_32x32x16_bf16 v[48:63], v[92:95], v[96:99], v[48:63]
    ds_read_b64_tr_b16 v[146:147], v170 offset:33792
    ds_read_b128 v[140:143], v162 offset:36864
    v_mfma_f32_4x4x4_16b_bf16 v[192:195], v[70:71], v[70:71], v[192:195]
    v_mfma_f32_4x4x4_16b_bf16 v[196:199], v[98:99], v[200:201], v[196:199]
    v_mfma_f32_32x32x16_bf16 v[32:47], v[100:103], v[108:111], v[32:47]
    ds_read_b128 v[148:151], v163 offset:32768
    ds_read_b64_tr_b16 v[156:157], v171 offset:32768
    v_mfma_f32_32x32x16_bf16 v[48:63], v[104:107], v[108:111], v[48:63]
    ds_read_b64_tr_b16 v[158:159], v171 offset:33792
    ds_read_b128 v[152:155], v163 offset:36864
    s_waitcnt lgkmcnt(0)
    v_mfma_f32_32x32x16_bf16 v[32:47], v[112:115], v[120:123], v[32:47]
    v_mfma_f32_4x4x4_16b_bf16 v[196:199], v[120:121], v[200:201], v[196:199]
    v_mfma_f32_4x4x4_16b_bf16 v[180:183], v[112:113], v[200:201], v[180:183]
    v_mfma_f32_32x32x16_bf16 v[48:63], v[116:119], v[120:123], v[48:63]
    v_mfma_f32_4x4x4_16b_bf16 v[184:187], v[112:113], v[112:113], v[184:187]
    v_mfma_f32_4x4x4_16b_bf16 v[188:191], v[116:117], v[200:201], v[188:191]
    v_mfma_f32_32x32x16_bf16 v[32:47], v[124:127], v[132:135], v[32:47]
    v_mfma_f32_4x4x4_16b_bf16 v[192:195], v[116:117], v[116:117], v[192:195]
    v_mfma_f32_4x4x4_16b_bf16 v[196:199], v[144:145], v[200:201], v[196:199]
    v_mfma_f32_32x32x16_bf16 v[48:63], v[128:131], v[132:135], v[48:63]
    s_nop 0
    v_mfma_f32_4x4x4_16b_bf16 v[196:199], v[122:123], v[200:201], v[196:199]
    v_mfma_f32_4x4x4_16b_bf16 v[180:183], v[114:115], v[200:201], v[180:183]
    v_mfma_f32_32x32x16_bf16 v[32:47], v[136:139], v[144:147], v[32:47]
    v_mfma_f32_4x4x4_16b_bf16 v[184:187], v[114:115], v[114:115], v[184:187]
    v_mfma_f32_4x4x4_16b_bf16 v[188:191], v[118:119], v[200:201], v[188:191]
    v_mfma_f32_32x32x16_bf16 v[48:63], v[140:143], v[144:147], v[48:63]
    v_mfma_f32_4x4x4_16b_bf16 v[192:195], v[118:119], v[118:119], v[192:195]
    v_mfma_f32_4x4x4_16b_bf16 v[196:199], v[146:147], v[200:201], v[196:199]
    v_mfma_f32_32x32x16_bf16 v[32:47], v[148:151], v[156:159], v[32:47]
    v_mfma_f32_32x32x16_bf16 v[48:63], v[152:155], v[156:159], v[48:63]
    v_and_b32 v4, 3, v1
    v_cmp_eq_u32 s[52:53], 1, v4
    v_cmp_eq_u32 s[54:55], 2, v4
    v_cmp_eq_u32 s[56:57], 3, v4
    v_cndmask_b32 v210, v196, v197, s[52:53]
    v_cndmask_b32 v206, v180, v181, s[52:53]
    v_cndmask_b32 v207, v184, v185, s[52:53]
    v_cndmask_b32 v208, v188, v189, s[52:53]
    v_cndmask_b32 v209, v192, v193, s[52:53]
    v_cndmask_b32 v210, v210, v198, s[54:55]
    v_cndmask_b32 v206, v206, v182, s[54:55]
    v_cndmask_b32 v207, v207, v186, s[54:55]
    v_cndmask_b32 v208, v208, v190, s[54:55]
    v_cndmask_b32 v209, v209, v194, s[54:55]
    v_cndmask_b32 v210, v210, v199, s[56:57]
    v_cndmask_b32 v206, v206, v183, s[56:57]
    v_cndmask_b32 v207, v207, v187, s[56:57]
    v_cndmask_b32 v208, v208, v191, s[56:57]
    v_cndmask_b32 v209, v209, v195, s[56:57]
    v_mov_b32 v64, v206
    s_nop 1
    v_permlane32_swap_b32 v206, v64
    v_add_f32 v206, v206, v64
    v_mov_b32 v64, v207
    s_nop 1
    v_permlane32_swap_b32 v207, v64
    v_add_f32 v207, v207, v64
    v_mov_b32 v64, v208
    s_nop 1
    v_permlane32_swap_b32 v208, v64
    v_add_f32 v208, v208, v64
    v_mov_b32 v64, v209
    s_nop 1
    v_permlane32_swap_b32 v209, v64
    v_add_f32 v209, v209, v64
    v_mov_b32 v64, v210
    s_nop 1
    v_permlane32_swap_b32 v210, v64
    v_add_f32 v210, v210, v64
    s_lshl_b32 s33, s30, 10
    s_lshl_b32 s34, s29, 9
    s_add_u32 s33, s33, s34
    s_add_u32 s33, s33, 133120
    v_lshlrev_b32 v65, 3, v2
    v_add_u32 v65, s33, v65
    ds_write_b64 v65, v[206:207]
    ds_write_b64 v65, v[208:209] offset:256
    s_lshl_b32 s33, s30, 7
    s_add_u32 s33, s33, 132096
    v_lshlrev_b32 v66, 2, v2
    v_add_u32 v66, s33, v66
    s_lshl_b32 s34, s29, 9
    v_add_u32 v67, s34, v66
    ds_write_b32 v67, v210
    s_waitcnt lgkmcnt(0)
    s_barrier
    ds_read_b32 v70, v66
    ds_read_b32 v71, v66 offset:512
    s_cmp_lt_u32 s28, 2
    s_cbranch_scc0 k1_nofin
    v_lshlrev_b32 v65, 3, v0
    v_add_u32 v65, 133120, v65
    ds_read_b64 v[72:73], v65
    ds_read_b64 v[74:75], v65 offset:1024
    ds_read_b64 v[76:77], v65 offset:2048
    ds_read_b64 v[78:79], v65 offset:3072
    s_waitcnt lgkmcnt(0)
    v_pk_add_f32 v[72:73], v[72:73], v[74:75]
    v_pk_add_f32 v[76:77], v[76:77], v[78:79]
    v_pk_add_f32 v[72:73], v[72:73], v[76:77]
    v_mul_f32 v72, 0x3acccccd, v72
    v_mul_f32 v73, 0x3acccccd, v73
    v_fma_f32 v73, -v72, v72, v73
    v_max_f32 v73, 0, v73
    v_cvt_pk_bf16_f32 v74, v72, v73
    v_lshlrev_b32 v72, 16, v74
    v_and_b32 v73, 0xffff0000, v74
    v_add_f32 v73, 0x3727c5ac, v73
    v_cvt_pk_bf16_f32 v74, v73, v73
    v_lshlrev_b32 v73, 16, v74
    v_sqrt_f32 v73, v73
    s_nop 0
    v_cvt_pk_bf16_f32 v74, v73, v73
    v_lshlrev_b32 v73, 16, v74
    v_rcp_f32 v73, v73
    v_lshlrev_b32 v65, 2, v0
    v_add_u32 v75, 131072, v65
    ds_write_b32 v75, v72
    ds_write_b32 v75, v73 offset:512
    s_cmp_lg_u32 s25, 0
    s_cbranch_scc1 k1_nofin
    v_lshlrev_b32 v65, 3, v0
    s_lshl_b32 s33, s24, 10
    s_add_u32 s33, s33, 25165824
    buffer_store_dwordx2 v[72:73], v65, s[20:23], s33 offen
k1_nofin:
    s_waitcnt lgkmcnt(0)
    v_add_f32 v70, v70, v71
    s_lshl_b32 s33, s29, 6
    v_lshlrev_b32 v68, 2, v3
    v_add_u32 v68, s33, v68
    v_lshlrev_b32 v68, 2, v68
    v_add_u32 v68, 131072, v68
    v_mov_b32 v71, v70
    s_lshl_b32 s34, s30, 5
    v_add_u32 v69, s34, v2
    v_lshlrev_b32 v69, 12, v69
    v_lshlrev_b32 v65, 3, v3
    v_add_u32 v65, s33, v65
    v_lshlrev_b32 v65, 1, v65
    v_add_u32 v69, v69, v65
    s_lshl_b32 s39, s25, 19
    s_lshl_b32 s33, s24, 12
    s_add_u32 s42, s39, s33
    s_lshl_b32 s33, s24, 8
    s_add_u32 s39, s39, s33
    v_lshrrev_b32 v66, 4, v1
    v_and_b32 v66, 1, v66
    s_lshl_b32 s33, s30, 1
    v_add_u32 v66, s33, v66
    v_lshlrev_b32 v66, 16, v66
    v_and_b32 v65, 15, v1
    v_lshl_add_u32 v66, v65, 4, v66
    v_lshl_add_u32 v66, v3, 8, v66
    s_lshl_b32 s33, s29, 11
    v_add_u32 v66, s33, v66
    s_barrier
    s_cmp_lt_u32 s25, 5
    s_cbranch_scc1 k1_phi
    s_cmp_lt_u32 s25, 10
    s_cbranch_scc1 k1_plain
    ds_read_b128 v[72:75], v68 offset:0
    ds_read_b128 v[88:91], v68 offset:512
    ds_read_b128 v[76:79], v68 offset:32
    ds_read_b128 v[92:95], v68 offset:544
    ds_read_b128 v[80:83], v68 offset:64
    ds_read_b128 v[96:99], v68 offset:576
    ds_read_b128 v[84:87], v68 offset:96
    ds_read_b128 v[100:103], v68 offset:608
    ds_read_b128 v[104:107], v68 offset:128
    ds_read_b128 v[120:123], v68 offset:640
    ds_read_b128 v[108:111], v68 offset:160
    ds_read_b128 v[124:127], v68 offset:672
    ds_read_b128 v[112:115], v68 offset:192
    ds_read_b128 v[128:131], v68 offset:704
    ds_read_b128 v[116:119], v68 offset:224
    ds_read_b128 v[132:135], v68 offset:736
    s_waitcnt lgkmcnt(8)
    v_pk_fma_f32 v[32:33], v[72:73], v[70:71], v[32:33] neg_lo:[1,0,0] neg_hi:[1,0,0]
    v_pk_fma_f32 v[34:35], v[74:75], v[70:71], v[34:35] neg_lo:[1,0,0] neg_hi:[1,0,0]
    v_pk_fma_f32 v[36:37], v[76:77], v[70:71], v[36:37] neg_lo:[1,0,0] neg_hi:[1,0,0]
    v_pk_fma_f32 v[38:39], v[78:79], v[70:71], v[38:39] neg_lo:[1,0,0] neg_hi:[1,0,0]
    v_pk_fma_f32 v[40:41], v[80:81], v[70:71], v[40:41] neg_lo:[1,0,0] neg_hi:[1,0,0]
    v_pk_fma_f32 v[42:43], v[82:83], v[70:71], v[42:43] neg_lo:[1,0,0] neg_hi:[1,0,0]
    v_pk_fma_f32 v[44:45], v[84:85], v[70:71], v[44:45] neg_lo:[1,0,0] neg_hi:[1,0,0]
    v_pk_fma_f32 v[46:47], v[86:87], v[70:71], v[46:47] neg_lo:[1,0,0] neg_hi:[1,0,0]
    v_pk_mul_f32 v[32:33], v[32:33], v[88:89]
    v_pk_mul_f32 v[34:35], v[34:35], v[90:91]
    v_pk_mul_f32 v[36:37], v[36:37], v[92:93]
    v_pk_mul_f32 v[38:39], v[38:39], v[94:95]
    v_pk_mul_f32 v[40:41], v[40:41], v[96:97]
    v_pk_mul_f32 v[42:43], v[42:43], v[98:99]
    v_pk_mul_f32 v[44:45], v[44:45], v[100:101]
    v_pk_mul_f32 v[46:47], v[46:47], v[102:103]
    v_cvt_pk_bf16_f32 v136, v32, v33
    v_cvt_pk_bf16_f32 v137, v34, v35
    v_cvt_pk_bf16_f32 v138, v36, v37
    v_cvt_pk_bf16_f32 v139, v38, v39
    v_cvt_pk_bf16_f32 v140, v40, v41
    v_cvt_pk_bf16_f32 v141, v42, v43
    v_cvt_pk_bf16_f32 v142, v44, v45
    v_cvt_pk_bf16_f32 v143, v46, v47
    v_lshlrev_b32 v32, 16, v136
    v_and_b32 v33, 0xffff0000, v136
    v_lshlrev_b32 v34, 16, v137
    v_and_b32 v35, 0xffff0000, v137
    v_lshlrev_b32 v36, 16, v138
    v_and_b32 v37, 0xffff0000, v138
    v_lshlrev_b32 v38, 16, v139
    v_and_b32 v39, 0xffff0000, v139
    v_lshlrev_b32 v40, 16, v140
    v_and_b32 v41, 0xffff0000, v140
    v_lshlrev_b32 v42, 16, v141
    v_and_b32 v43, 0xffff0000, v141
    v_lshlrev_b32 v44, 16, v142
    v_and_b32 v45, 0xffff0000, v142
    v_lshlrev_b32 v46, 16, v143
    v_and_b32 v47, 0xffff0000, v143
    v_pk_mul_f32 v[152:153], v[32:33], v[32:33]
    v_pk_mul_f32 v[154:155], v[34:35], v[34:35]
    v_pk_mul_f32 v[156:157], v[36:37], v[36:37]
    v_pk_mul_f32 v[158:159], v[38:39], v[38:39]
    v_pk_mul_f32 v[160:161], v[40:41], v[40:41]
    v_pk_mul_f32 v[162:163], v[42:43], v[42:43]
    v_pk_mul_f32 v[164:165], v[44:45], v[44:45]
    v_pk_mul_f32 v[166:167], v[46:47], v[46:47]
    v_pk_mul_f32 v[168:169], v[32:33], v[248:249]
    v_pk_mul_f32 v[170:171], v[34:35], v[248:249]
    v_pk_mul_f32 v[172:173], v[36:37], v[248:249]
    v_pk_mul_f32 v[174:175], v[38:39], v[248:249]
    v_pk_mul_f32 v[176:177], v[40:41], v[248:249]
    v_pk_mul_f32 v[178:179], v[42:43], v[248:249]
    v_pk_mul_f32 v[180:181], v[44:45], v[248:249]
    v_pk_mul_f32 v[182:183], v[46:47], v[248:249]
    v_pk_fma_f32 v[152:153], v[152:153], v[246:247], v[240:241]
    v_pk_fma_f32 v[154:155], v[154:155], v[246:247], v[240:241]
    v_pk_fma_f32 v[156:157], v[156:157], v[246:247], v[240:241]
    v_pk_fma_f32 v[158:159], v[158:159], v[246:247], v[240:241]
    v_pk_fma_f32 v[160:161], v[160:161], v[246:247], v[240:241]
    v_pk_fma_f32 v[162:163], v[162:163], v[246:247], v[240:241]
    v_pk_fma_f32 v[164:165], v[164:165], v[246:247], v[240:241]
    v_pk_fma_f32 v[166:167], v[166:167], v[246:247], v[240:241]
    v_pk_mul_f32 v[152:153], v[152:153], v[168:169]
    v_pk_mul_f32 v[154:155], v[154:155], v[170:171]
    v_pk_mul_f32 v[156:157], v[156:157], v[172:173]
    v_pk_mul_f32 v[158:159], v[158:159], v[174:175]
    v_pk_mul_f32 v[160:161], v[160:161], v[176:177]
    v_pk_mul_f32 v[162:163], v[162:163], v[178:179]
    v_pk_mul_f32 v[164:165], v[164:165], v[180:181]
    v_pk_mul_f32 v[166:167], v[166:167], v[182:183]
    v_exp_f32 v152, v152
    v_exp_f32 v153, v153
    v_exp_f32 v154, v154
    v_exp_f32 v155, v155
    v_exp_f32 v156, v156
    v_exp_f32 v157, v157
    v_exp_f32 v158, v158
    v_exp_f32 v159, v159
    v_exp_f32 v160, v160
    v_exp_f32 v161, v161
    v_exp_f32 v162, v162
    v_exp_f32 v163, v163
    v_exp_f32 v164, v164
    v_exp_f32 v165, v165
    v_exp_f32 v166, v166
    v_exp_f32 v167, v167
    v_pk_add_f32 v[152:153], v[152:153], v[240:241]
    v_pk_add_f32 v[154:155], v[154:155], v[240:241]
    v_pk_add_f32 v[156:157], v[156:157], v[240:241]
    v_pk_add_f32 v[158:159], v[158:159], v[240:241]
    v_pk_add_f32 v[160:161], v[160:161], v[240:241]
    v_pk_add_f32 v[162:163], v[162:163], v[240:241]
    v_pk_add_f32 v[164:165], v[164:165], v[240:241]
    v_pk_add_f32 v[166:167], v[166:167], v[240:241]
    v_rcp_f32 v152, v152
    v_rcp_f32 v153, v153
    v_rcp_f32 v154, v154
    v_rcp_f32 v155, v155
    v_rcp_f32 v156, v156
    v_rcp_f32 v157, v157
    v_rcp_f32 v158, v158
    v_rcp_f32 v159, v159
    v_rcp_f32 v160, v160
    v_rcp_f32 v161, v161
    v_rcp_f32 v162, v162
    v_rcp_f32 v163, v163
    v_rcp_f32 v164, v164
    v_rcp_f32 v165, v165
    v_rcp_f32 v166, v166
    v_rcp_f32 v167, v167
    v_pk_mul_f32 v[152:153], v[152:153], v[32:33]
    v_pk_mul_f32 v[154:155], v[154:155], v[34:35]
    v_pk_mul_f32 v[156:157], v[156:157], v[36:37]
    v_pk_mul_f32 v[158:159], v[158:159], v[38:39]
    v_pk_mul_f32 v[160:161], v[160:161], v[40:41]
    v_pk_mul_f32 v[162:163], v[162:163], v[42:43]
    v_pk_mul_f32 v[164:165], v[164:165], v[44:45]
    v_pk_mul_f32 v[166:167], v[166:167], v[46:47]
    v_cvt_pk_bf16_f32 v144, v152, v153
    v_cvt_pk_bf16_f32 v145, v154, v155
    v_cvt_pk_bf16_f32 v146, v156, v157
    v_cvt_pk_bf16_f32 v147, v158, v159
    v_cvt_pk_bf16_f32 v148, v160, v161
    v_cvt_pk_bf16_f32 v149, v162, v163
    v_cvt_pk_bf16_f32 v150, v164, v165
    v_cvt_pk_bf16_f32 v151, v166, v167
    v_permlane32_swap_b32 v144, v146
    v_permlane32_swap_b32 v145, v147
    v_permlane32_swap_b32 v148, v150
    v_permlane32_swap_b32 v149, v151
    buffer_store_dwordx4 v[144:147], v69, s[20:23], s39 offen offset:0
    buffer_store_dwordx4 v[148:151], v69, s[20:23], s39 offen offset:32
    s_waitcnt lgkmcnt(0)
    v_pk_fma_f32 v[48:49], v[104:105], v[70:71], v[48:49] neg_lo:[1,0,0] neg_hi:[1,0,0]
    v_pk_fma_f32 v[50:51], v[106:107], v[70:71], v[50:51] neg_lo:[1,0,0] neg_hi:[1,0,0]
    v_pk_fma_f32 v[52:53], v[108:109], v[70:71], v[52:53] neg_lo:[1,0,0] neg_hi:[1,0,0]
    v_pk_fma_f32 v[54:55], v[110:111], v[70:71], v[54:55] neg_lo:[1,0,0] neg_hi:[1,0,0]
    v_pk_fma_f32 v[56:57], v[112:113], v[70:71], v[56:57] neg_lo:[1,0,0] neg_hi:[1,0,0]
    v_pk_fma_f32 v[58:59], v[114:115], v[70:71], v[58:59] neg_lo:[1,0,0] neg_hi:[1,0,0]
    v_pk_fma_f32 v[60:61], v[116:117], v[70:71], v[60:61] neg_lo:[1,0,0] neg_hi:[1,0,0]
    v_pk_fma_f32 v[62:63], v[118:119], v[70:71], v[62:63] neg_lo:[1,0,0] neg_hi:[1,0,0]
    v_pk_mul_f32 v[48:49], v[48:49], v[120:121]
    v_pk_mul_f32 v[50:51], v[50:51], v[122:123]
    v_pk_mul_f32 v[52:53], v[52:53], v[124:125]
    v_pk_mul_f32 v[54:55], v[54:55], v[126:127]
    v_pk_mul_f32 v[56:57], v[56:57], v[128:129]
    v_pk_mul_f32 v[58:59], v[58:59], v[130:131]
    v_pk_mul_f32 v[60:61], v[60:61], v[132:133]
    v_pk_mul_f32 v[62:63], v[62:63], v[134:135]
    v_cvt_pk_bf16_f32 v184, v48, v49
    v_cvt_pk_bf16_f32 v185, v50, v51
    v_cvt_pk_bf16_f32 v186, v52, v53
    v_cvt_pk_bf16_f32 v187, v54, v55
    v_cvt_pk_bf16_f32 v188, v56, v57
    v_cvt_pk_bf16_f32 v189, v58, v59
    v_cvt_pk_bf16_f32 v190, v60, v61
    v_cvt_pk_bf16_f32 v191, v62, v63
    v_lshlrev_b32 v48, 16, v184
    v_and_b32 v49, 0xffff0000, v184
    v_lshlrev_b32 v50, 16, v185
    v_and_b32 v51, 0xffff0000, v185
    v_lshlrev_b32 v52, 16, v186
    v_and_b32 v53, 0xffff0000, v186
    v_lshlrev_b32 v54, 16, v187
    v_and_b32 v55, 0xffff0000, v187
    v_lshlrev_b32 v56, 16, v188
    v_and_b32 v57, 0xffff0000, v188
    v_lshlrev_b32 v58, 16, v189
    v_and_b32 v59, 0xffff0000, v189
    v_lshlrev_b32 v60, 16, v190
    v_and_b32 v61, 0xffff0000, v190
    v_lshlrev_b32 v62, 16, v191
    v_and_b32 v63, 0xffff0000, v191
    v_pk_mul_f32 v[200:201], v[48:49], v[48:49]
    v_pk_mul_f32 v[202:203], v[50:51], v[50:51]
    v_pk_mul_f32 v[204:205], v[52:53], v[52:53]
    v_pk_mul_f32 v[206:207], v[54:55], v[54:55]
    v_pk_mul_f32 v[208:209], v[56:57], v[56:57]
    v_pk_mul_f32 v[210:211], v[58:59], v[58:59]
    v_pk_mul_f32 v[212:213], v[60:61], v[60:61]
    v_pk_mul_f32 v[214:215], v[62:63], v[62:63]
    v_pk_mul_f32 v[216:217], v[48:49], v[248:249]
    v_pk_mul_f32 v[218:219], v[50:51], v[248:249]
    v_pk_mul_f32 v[220:221], v[52:53], v[248:249]
    v_pk_mul_f32 v[222:223], v[54:55], v[248:249]
    v_pk_mul_f32 v[224:225], v[56:57], v[248:249]
    v_pk_mul_f32 v[226:227], v[58:59], v[248:249]
    v_pk_mul_f32 v[228:229], v[60:61], v[248:249]
    v_pk_mul_f32 v[230:231], v[62:63], v[248:249]
    v_pk_fma_f32 v[200:201], v[200:201], v[246:247], v[240:241]
    v_pk_fma_f32 v[202:203], v[202:203], v[246:247], v[240:241]
    v_pk_fma_f32 v[204:205], v[204:205], v[246:247], v[240:241]
    v_pk_fma_f32 v[206:207], v[206:207], v[246:247], v[240:241]
    v_pk_fma_f32 v[208:209], v[208:209], v[246:247], v[240:241]
    v_pk_fma_f32 v[210:211], v[210:211], v[246:247], v[240:241]
    v_pk_fma_f32 v[212:213], v[212:213], v[246:247], v[240:241]
    v_pk_fma_f32 v[214:215], v[214:215], v[246:247], v[240:241]
    v_pk_mul_f32 v[200:201], v[200:201], v[216:217]
    v_pk_mul_f32 v[202:203], v[202:203], v[218:219]
    v_pk_mul_f32 v[204:205], v[204:205], v[220:221]
    v_pk_mul_f32 v[206:207], v[206:207], v[222:223]
    v_pk_mul_f32 v[208:209], v[208:209], v[224:225]
    v_pk_mul_f32 v[210:211], v[210:211], v[226:227]
    v_pk_mul_f32 v[212:213], v[212:213], v[228:229]
    v_pk_mul_f32 v[214:215], v[214:215], v[230:231]
    v_exp_f32 v200, v200
    v_exp_f32 v201, v201
    v_exp_f32 v202, v202
    v_exp_f32 v203, v203
    v_exp_f32 v204, v204
    v_exp_f32 v205, v205
    v_exp_f32 v206, v206
    v_exp_f32 v207, v207
    v_exp_f32 v208, v208
    v_exp_f32 v209, v209
    v_exp_f32 v210, v210
    v_exp_f32 v211, v211
    v_exp_f32 v212, v212
    v_exp_f32 v213, v213
    v_exp_f32 v214, v214
    v_exp_f32 v215, v215
    v_pk_add_f32 v[200:201], v[200:201], v[240:241]
    v_pk_add_f32 v[202:203], v[202:203], v[240:241]
    v_pk_add_f32 v[204:205], v[204:205], v[240:241]
    v_pk_add_f32 v[206:207], v[206:207], v[240:241]
    v_pk_add_f32 v[208:209], v[208:209], v[240:241]
    v_pk_add_f32 v[210:211], v[210:211], v[240:241]
    v_pk_add_f32 v[212:213], v[212:213], v[240:241]
    v_pk_add_f32 v[214:215], v[214:215], v[240:241]
    v_rcp_f32 v200, v200
    v_rcp_f32 v201, v201
    v_rcp_f32 v202, v202
    v_rcp_f32 v203, v203
    v_rcp_f32 v204, v204
    v_rcp_f32 v205, v205
    v_rcp_f32 v206, v206
    v_rcp_f32 v207, v207
    v_rcp_f32 v208, v208
    v_rcp_f32 v209, v209
    v_rcp_f32 v210, v210
    v_rcp_f32 v211, v211
    v_rcp_f32 v212, v212
    v_rcp_f32 v213, v213
    v_rcp_f32 v214, v214
    v_rcp_f32 v215, v215
    v_pk_mul_f32 v[200:201], v[200:201], v[48:49]
    v_pk_mul_f32 v[202:203], v[202:203], v[50:51]
    v_pk_mul_f32 v[204:205], v[204:205], v[52:53]
    v_pk_mul_f32 v[206:207], v[206:207], v[54:55]
    v_pk_mul_f32 v[208:209], v[208:209], v[56:57]
    v_pk_mul_f32 v[210:211], v[210:211], v[58:59]
    v_pk_mul_f32 v[212:213], v[212:213], v[60:61]
    v_pk_mul_f32 v[214:215], v[214:215], v[62:63]
    v_cvt_pk_bf16_f32 v192, v200, v201
    v_cvt_pk_bf16_f32 v193, v202, v203
    v_cvt_pk_bf16_f32 v194, v204, v205
    v_cvt_pk_bf16_f32 v195, v206, v207
    v_cvt_pk_bf16_f32 v196, v208, v209
    v_cvt_pk_bf16_f32 v197, v210, v211
    v_cvt_pk_bf16_f32 v198, v212, v213
    v_cvt_pk_bf16_f32 v199, v214, v215
    v_permlane32_swap_b32 v192, v194
    v_permlane32_swap_b32 v193, v195
    v_permlane32_swap_b32 v196, v198
    v_permlane32_swap_b32 v197, v199
    buffer_store_dwordx4 v[192:195], v69, s[20:23], s39 offen offset:64
    buffer_store_dwordx4 v[196:199], v69, s[20:23], s39 offen offset:96
    s_endpgm
k1_phi:
    s_nop 4
    ds_read_b128 v[72:75], v68 offset:0
    ds_read_b128 v[88:91], v68 offset:512
    ds_read_b128 v[76:79], v68 offset:32
    ds_read_b128 v[92:95], v68 offset:544
    ds_read_b128 v[80:83], v68 offset:64
    ds_read_b128 v[96:99], v68 offset:576
    ds_read_b128 v[84:87], v68 offset:96
    ds_read_b128 v[100:103], v68 offset:608
    ds_read_b128 v[104:107], v68 offset:128
    ds_read_b128 v[120:123], v68 offset:640
    ds_read_b128 v[108:111], v68 offset:160
    ds_read_b128 v[124:127], v68 offset:672
    ds_read_b128 v[112:115], v68 offset:192
    ds_read_b128 v[128:131], v68 offset:704
    ds_read_b128 v[116:119], v68 offset:224
    ds_read_b128 v[132:135], v68 offset:736
    s_waitcnt lgkmcnt(8)
    v_pk_fma_f32 v[32:33], v[72:73], v[70:71], v[32:33] neg_lo:[1,0,0] neg_hi:[1,0,0]
    v_pk_fma_f32 v[34:35], v[74:75], v[70:71], v[34:35] neg_lo:[1,0,0] neg_hi:[1,0,0]
    v_pk_fma_f32 v[36:37], v[76:77], v[70:71], v[36:37] neg_lo:[1,0,0] neg_hi:[1,0,0]
    v_pk_fma_f32 v[38:39], v[78:79], v[70:71], v[38:39] neg_lo:[1,0,0] neg_hi:[1,0,0]
    v_pk_fma_f32 v[40:41], v[80:81], v[70:71], v[40:41] neg_lo:[1,0,0] neg_hi:[1,0,0]
    v_pk_fma_f32 v[42:43], v[82:83], v[70:71], v[42:43] neg_lo:[1,0,0] neg_hi:[1,0,0]
    v_pk_fma_f32 v[44:45], v[84:85], v[70:71], v[44:45] neg_lo:[1,0,0] neg_hi:[1,0,0]
    v_pk_fma_f32 v[46:47], v[86:87], v[70:71], v[46:47] neg_lo:[1,0,0] neg_hi:[1,0,0]
    v_pk_mul_f32 v[32:33], v[32:33], v[88:89]
    v_pk_mul_f32 v[34:35], v[34:35], v[90:91]
    v_pk_mul_f32 v[36:37], v[36:37], v[92:93]
    v_pk_mul_f32 v[38:39], v[38:39], v[94:95]
    v_pk_mul_f32 v[40:41], v[40:41], v[96:97]
    v_pk_mul_f32 v[42:43], v[42:43], v[98:99]
    v_pk_mul_f32 v[44:45], v[44:45], v[100:101]
    v_pk_mul_f32 v[46:47], v[46:47], v[102:103]
    v_cvt_pk_bf16_f32 v136, v32, v33
    v_cvt_pk_bf16_f32 v137, v34, v35
    v_cvt_pk_bf16_f32 v138, v36, v37
    v_cvt_pk_bf16_f32 v139, v38, v39
    v_cvt_pk_bf16_f32 v140, v40, v41
    v_cvt_pk_bf16_f32 v141, v42, v43
    v_cvt_pk_bf16_f32 v142, v44, v45
    v_cvt_pk_bf16_f32 v143, v46, v47
    v_lshlrev_b32 v32, 16, v136
    v_and_b32 v33, 0xffff0000, v136
    v_lshlrev_b32 v34, 16, v137
    v_and_b32 v35, 0xffff0000, v137
    v_lshlrev_b32 v36, 16, v138
    v_and_b32 v37, 0xffff0000, v138
    v_lshlrev_b32 v38, 16, v139
    v_and_b32 v39, 0xffff0000, v139
    v_lshlrev_b32 v40, 16, v140
    v_and_b32 v41, 0xffff0000, v140
    v_lshlrev_b32 v42, 16, v141
    v_and_b32 v43, 0xffff0000, v141
    v_lshlrev_b32 v44, 16, v142
    v_and_b32 v45, 0xffff0000, v142
    v_lshlrev_b32 v46, 16, v143
    v_and_b32 v47, 0xffff0000, v143
    v_pk_mul_f32 v[152:153], v[32:33], v[242:243]
    v_pk_mul_f32 v[154:155], v[34:35], v[242:243]
    v_pk_mul_f32 v[156:157], v[36:37], v[242:243]
    v_pk_mul_f32 v[158:159], v[38:39], v[242:243]
    v_pk_mul_f32 v[160:161], v[40:41], v[242:243]
    v_pk_mul_f32 v[162:163], v[42:43], v[242:243]
    v_pk_mul_f32 v[164:165], v[44:45], v[242:243]
    v_pk_mul_f32 v[166:167], v[46:47], v[242:243]
    v_exp_f32 v152, v152
    v_exp_f32 v153, v153
    v_exp_f32 v154, v154
    v_exp_f32 v155, v155
    v_exp_f32 v156, v156
    v_exp_f32 v157, v157
    v_exp_f32 v158, v158
    v_exp_f32 v159, v159
    v_exp_f32 v160, v160
    v_exp_f32 v161, v161
    v_exp_f32 v162, v162
    v_exp_f32 v163, v163
    v_exp_f32 v164, v164
    v_exp_f32 v165, v165
    v_exp_f32 v166, v166
    v_exp_f32 v167, v167
    v_pk_add_f32 v[168:169], v[32:33], v[240:241]
    v_pk_add_f32 v[170:171], v[34:35], v[240:241]
    v_pk_add_f32 v[172:173], v[36:37], v[240:241]
    v_pk_add_f32 v[174:175], v[38:39], v[240:241]
    v_pk_add_f32 v[176:177], v[40:41], v[240:241]
    v_pk_add_f32 v[178:179], v[42:43], v[240:241]
    v_pk_add_f32 v[180:181], v[44:45], v[240:241]
    v_pk_add_f32 v[182:183], v[46:47], v[240:241]
    v_cvt_pk_bf16_f32 v136, v152, v153
    v_cvt_pk_bf16_f32 v137, v154, v155
    v_cvt_pk_bf16_f32 v138, v156, v157
    v_cvt_pk_bf16_f32 v139, v158, v159
    v_cvt_pk_bf16_f32 v140, v160, v161
    v_cvt_pk_bf16_f32 v141, v162, v163
    v_cvt_pk_bf16_f32 v142, v164, v165
    v_cvt_pk_bf16_f32 v143, v166, v167
    v_lshlrev_b32 v152, 16, v136
    v_and_b32 v153, 0xffff0000, v136
    v_lshlrev_b32 v154, 16, v137
    v_and_b32 v155, 0xffff0000, v137
    v_lshlrev_b32 v156, 16, v138
    v_and_b32 v157, 0xffff0000, v138
    v_lshlrev_b32 v158, 16, v139
    v_and_b32 v159, 0xffff0000, v139
    v_lshlrev_b32 v160, 16, v140
    v_and_b32 v161, 0xffff0000, v140
    v_lshlrev_b32 v162, 16, v141
    v_and_b32 v163, 0xffff0000, v141
    v_lshlrev_b32 v164, 16, v142
    v_and_b32 v165, 0xffff0000, v142
    v_lshlrev_b32 v166, 16, v143
    v_and_b32 v167, 0xffff0000, v143
    v_pk_add_f32 v[152:153], v[152:153], v[244:245]
    v_pk_add_f32 v[154:155], v[154:155], v[244:245]
    v_pk_add_f32 v[156:157], v[156:157], v[244:245]
    v_pk_add_f32 v[158:159], v[158:159], v[244:245]
    v_pk_add_f32 v[160:161], v[160:161], v[244:245]
    v_pk_add_f32 v[162:163], v[162:163], v[244:245]
    v_pk_add_f32 v[164:165], v[164:165], v[244:245]
    v_pk_add_f32 v[166:167], v[166:167], v[244:245]
    v_cmp_lt_f32 s[52:53], 0, v32
    v_cmp_lt_f32 s[54:55], 0, v33
    v_cmp_lt_f32 s[56:57], 0, v34
    v_cmp_lt_f32 s[58:59], 0, v35
    v_cndmask_b32 v152, v152, v168, s[52:53]
    v_cndmask_b32 v153, v153, v169, s[54:55]
    v_cndmask_b32 v154, v154, v170, s[56:57]
    v_cndmask_b32 v155, v155, v171, s[58:59]
    v_cmp_lt_f32 s[52:53], 0, v36
    v_cmp_lt_f32 s[54:55], 0, v37
    v_cmp_lt_f32 s[56:57], 0, v38
    v_cmp_lt_f32 s[58:59], 0, v39
    v_cndmask_b32 v156, v156, v172, s[52:53]
    v_cndmask_b32 v157, v157, v173, s[54:55]
    v_cndmask_b32 v158, v158, v174, s[56:57]
    v_cndmask_b32 v159, v159, v175, s[58:59]
    v_cmp_lt_f32 s[52:53], 0, v40
    v_cmp_lt_f32 s[54:55], 0, v41
    v_cmp_lt_f32 s[56:57], 0, v42
    v_cmp_lt_f32 s[58:59], 0, v43
    v_cndmask_b32 v160, v160, v176, s[52:53]
    v_cndmask_b32 v161, v161, v177, s[54:55]
    v_cndmask_b32 v162, v162, v178, s[56:57]
    v_cndmask_b32 v163, v163, v179, s[58:59]
    v_cmp_lt_f32 s[52:53], 0, v44
    v_cmp_lt_f32 s[54:55], 0, v45
    v_cmp_lt_f32 s[56:57], 0, v46
    v_cmp_lt_f32 s[58:59], 0, v47
    v_cndmask_b32 v164, v164, v180, s[52:53]
    v_cndmask_b32 v165, v165, v181, s[54:55]
    v_cndmask_b32 v166, v166, v182, s[56:57]
    v_cndmask_b32 v167, v167, v183, s[58:59]
    v_cvt_pk_bf16_f32 v144, v152, v153
    v_cvt_pk_bf16_f32 v145, v154, v155
    v_cvt_pk_bf16_f32 v146, v156, v157
    v_cvt_pk_bf16_f32 v147, v158, v159
    v_cvt_pk_bf16_f32 v148, v160, v161
    v_cvt_pk_bf16_f32 v149, v162, v163
    v_cvt_pk_bf16_f32 v150, v164, v165
    v_cvt_pk_bf16_f32 v151, v166, v167
    v_permlane32_swap_b32 v144, v146
    v_permlane32_swap_b32 v145, v147
    v_permlane32_swap_b32 v148, v150
    v_permlane32_swap_b32 v149, v151
    buffer_store_dwordx4 v[144:147], v66, s[20:23], s42 offen offset:0
    buffer_store_dwordx4 v[148:151], v66, s[20:23], s42 offen offset:512
    s_waitcnt lgkmcnt(0)
    v_pk_fma_f32 v[48:49], v[104:105], v[70:71], v[48:49] neg_lo:[1,0,0] neg_hi:[1,0,0]
    v_pk_fma_f32 v[50:51], v[106:107], v[70:71], v[50:51] neg_lo:[1,0,0] neg_hi:[1,0,0]
    v_pk_fma_f32 v[52:53], v[108:109], v[70:71], v[52:53] neg_lo:[1,0,0] neg_hi:[1,0,0]
    v_pk_fma_f32 v[54:55], v[110:111], v[70:71], v[54:55] neg_lo:[1,0,0] neg_hi:[1,0,0]
    v_pk_fma_f32 v[56:57], v[112:113], v[70:71], v[56:57] neg_lo:[1,0,0] neg_hi:[1,0,0]
    v_pk_fma_f32 v[58:59], v[114:115], v[70:71], v[58:59] neg_lo:[1,0,0] neg_hi:[1,0,0]
    v_pk_fma_f32 v[60:61], v[116:117], v[70:71], v[60:61] neg_lo:[1,0,0] neg_hi:[1,0,0]
    v_pk_fma_f32 v[62:63], v[118:119], v[70:71], v[62:63] neg_lo:[1,0,0] neg_hi:[1,0,0]
    v_pk_mul_f32 v[48:49], v[48:49], v[120:121]
    v_pk_mul_f32 v[50:51], v[50:51], v[122:123]
    v_pk_mul_f32 v[52:53], v[52:53], v[124:125]
    v_pk_mul_f32 v[54:55], v[54:55], v[126:127]
    v_pk_mul_f32 v[56:57], v[56:57], v[128:129]
    v_pk_mul_f32 v[58:59], v[58:59], v[130:131]
    v_pk_mul_f32 v[60:61], v[60:61], v[132:133]
    v_pk_mul_f32 v[62:63], v[62:63], v[134:135]
    v_cvt_pk_bf16_f32 v184, v48, v49
    v_cvt_pk_bf16_f32 v185, v50, v51
    v_cvt_pk_bf16_f32 v186, v52, v53
    v_cvt_pk_bf16_f32 v187, v54, v55
    v_cvt_pk_bf16_f32 v188, v56, v57
    v_cvt_pk_bf16_f32 v189, v58, v59
    v_cvt_pk_bf16_f32 v190, v60, v61
    v_cvt_pk_bf16_f32 v191, v62, v63
    v_lshlrev_b32 v48, 16, v184
    v_and_b32 v49, 0xffff0000, v184
    v_lshlrev_b32 v50, 16, v185
    v_and_b32 v51, 0xffff0000, v185
    v_lshlrev_b32 v52, 16, v186
    v_and_b32 v53, 0xffff0000, v186
    v_lshlrev_b32 v54, 16, v187
    v_and_b32 v55, 0xffff0000, v187
    v_lshlrev_b32 v56, 16, v188
    v_and_b32 v57, 0xffff0000, v188
    v_lshlrev_b32 v58, 16, v189
    v_and_b32 v59, 0xffff0000, v189
    v_lshlrev_b32 v60, 16, v190
    v_and_b32 v61, 0xffff0000, v190
    v_lshlrev_b32 v62, 16, v191
    v_and_b32 v63, 0xffff0000, v191
    v_pk_mul_f32 v[200:201], v[48:49], v[242:243]
    v_pk_mul_f32 v[202:203], v[50:51], v[242:243]
    v_pk_mul_f32 v[204:205], v[52:53], v[242:243]
    v_pk_mul_f32 v[206:207], v[54:55], v[242:243]
    v_pk_mul_f32 v[208:209], v[56:57], v[242:243]
    v_pk_mul_f32 v[210:211], v[58:59], v[242:243]
    v_pk_mul_f32 v[212:213], v[60:61], v[242:243]
    v_pk_mul_f32 v[214:215], v[62:63], v[242:243]
    v_exp_f32 v200, v200
    v_exp_f32 v201, v201
    v_exp_f32 v202, v202
    v_exp_f32 v203, v203
    v_exp_f32 v204, v204
    v_exp_f32 v205, v205
    v_exp_f32 v206, v206
    v_exp_f32 v207, v207
    v_exp_f32 v208, v208
    v_exp_f32 v209, v209
    v_exp_f32 v210, v210
    v_exp_f32 v211, v211
    v_exp_f32 v212, v212
    v_exp_f32 v213, v213
    v_exp_f32 v214, v214
    v_exp_f32 v215, v215
    v_pk_add_f32 v[216:217], v[48:49], v[240:241]
    v_pk_add_f32 v[218:219], v[50:51], v[240:241]
    v_pk_add_f32 v[220:221], v[52:53], v[240:241]
    v_pk_add_f32 v[222:223], v[54:55], v[240:241]
    v_pk_add_f32 v[224:225], v[56:57], v[240:241]
    v_pk_add_f32 v[226:227], v[58:59], v[240:241]
    v_pk_add_f32 v[228:229], v[60:61], v[240:241]
    v_pk_add_f32 v[230:231], v[62:63], v[240:241]
    v_cvt_pk_bf16_f32 v184, v200, v201
    v_cvt_pk_bf16_f32 v185, v202, v203
    v_cvt_pk_bf16_f32 v186, v204, v205
    v_cvt_pk_bf16_f32 v187, v206, v207
    v_cvt_pk_bf16_f32 v188, v208, v209
    v_cvt_pk_bf16_f32 v189, v210, v211
    v_cvt_pk_bf16_f32 v190, v212, v213
    v_cvt_pk_bf16_f32 v191, v214, v215
    v_lshlrev_b32 v200, 16, v184
    v_and_b32 v201, 0xffff0000, v184
    v_lshlrev_b32 v202, 16, v185
    v_and_b32 v203, 0xffff0000, v185
    v_lshlrev_b32 v204, 16, v186
    v_and_b32 v205, 0xffff0000, v186
    v_lshlrev_b32 v206, 16, v187
    v_and_b32 v207, 0xffff0000, v187
    v_lshlrev_b32 v208, 16, v188
    v_and_b32 v209, 0xffff0000, v188
    v_lshlrev_b32 v210, 16, v189
    v_and_b32 v211, 0xffff0000, v189
    v_lshlrev_b32 v212, 16, v190
    v_and_b32 v213, 0xffff0000, v190
    v_lshlrev_b32 v214, 16, v191
    v_and_b32 v215, 0xffff0000, v191
    v_pk_add_f32 v[200:201], v[200:201], v[244:245]
    v_pk_add_f32 v[202:203], v[202:203], v[244:245]
    v_pk_add_f32 v[204:205], v[204:205], v[244:245]
    v_pk_add_f32 v[206:207], v[206:207], v[244:245]
    v_pk_add_f32 v[208:209], v[208:209], v[244:245]
    v_pk_add_f32 v[210:211], v[210:211], v[244:245]
    v_pk_add_f32 v[212:213], v[212:213], v[244:245]
    v_pk_add_f32 v[214:215], v[214:215], v[244:245]
    v_cmp_lt_f32 s[52:53], 0, v48
    v_cmp_lt_f32 s[54:55], 0, v49
    v_cmp_lt_f32 s[56:57], 0, v50
    v_cmp_lt_f32 s[58:59], 0, v51
    v_cndmask_b32 v200, v200, v216, s[52:53]
    v_cndmask_b32 v201, v201, v217, s[54:55]
    v_cndmask_b32 v202, v202, v218, s[56:57]
    v_cndmask_b32 v203, v203, v219, s[58:59]
    v_cmp_lt_f32 s[52:53], 0, v52
    v_cmp_lt_f32 s[54:55], 0, v53
    v_cmp_lt_f32 s[56:57], 0, v54
    v_cmp_lt_f32 s[58:59], 0, v55
    v_cndmask_b32 v204, v204, v220, s[52:53]
    v_cndmask_b32 v205, v205, v221, s[54:55]
    v_cndmask_b32 v206, v206, v222, s[56:57]
    v_cndmask_b32 v207, v207, v223, s[58:59]
    v_cmp_lt_f32 s[52:53], 0, v56
    v_cmp_lt_f32 s[54:55], 0, v57
    v_cmp_lt_f32 s[56:57], 0, v58
    v_cmp_lt_f32 s[58:59], 0, v59
    v_cndmask_b32 v208, v208, v224, s[52:53]
    v_cndmask_b32 v209, v209, v225, s[54:55]
    v_cndmask_b32 v210, v210, v226, s[56:57]
    v_cndmask_b32 v211, v211, v227, s[58:59]
    v_cmp_lt_f32 s[52:53], 0, v60
    v_cmp_lt_f32 s[54:55], 0, v61
    v_cmp_lt_f32 s[56:57], 0, v62
    v_cmp_lt_f32 s[58:59], 0, v63
    v_cndmask_b32 v212, v212, v228, s[52:53]
    v_cndmask_b32 v213, v213, v229, s[54:55]
    v_cndmask_b32 v214, v214, v230, s[56:57]
    v_cndmask_b32 v215, v215, v231, s[58:59]
    v_cvt_pk_bf16_f32 v192, v200, v201
    v_cvt_pk_bf16_f32 v193, v202, v203
    v_cvt_pk_bf16_f32 v194, v204, v205
    v_cvt_pk_bf16_f32 v195, v206, v207
    v_cvt_pk_bf16_f32 v196, v208, v209
    v_cvt_pk_bf16_f32 v197, v210, v211
    v_cvt_pk_bf16_f32 v198, v212, v213
    v_cvt_pk_bf16_f32 v199, v214, v215
    v_permlane32_swap_b32 v192, v194
    v_permlane32_swap_b32 v193, v195
    v_permlane32_swap_b32 v196, v198
    v_permlane32_swap_b32 v197, v199
    buffer_store_dwordx4 v[192:195], v66, s[20:23], s42 offen offset:1024
    buffer_store_dwordx4 v[196:199], v66, s[20:23], s42 offen offset:1536
    s_endpgm
k1_plain:
    s_nop 4
    ds_read_b128 v[72:75], v68 offset:0
    ds_read_b128 v[88:91], v68 offset:512
    ds_read_b128 v[76:79], v68 offset:32
    ds_read_b128 v[92:95], v68 offset:544
    ds_read_b128 v[80:83], v68 offset:64
    ds_read_b128 v[96:99], v68 offset:576
    ds_read_b128 v[84:87], v68 offset:96
    ds_read_b128 v[100:103], v68 offset:608
    ds_read_b128 v[104:107], v68 offset:128
    ds_read_b128 v[120:123], v68 offset:640
    ds_read_b128 v[108:111], v68 offset:160
    ds_read_b128 v[124:127], v68 offset:672
    ds_read_b128 v[112:115], v68 offset:192
    ds_read_b128 v[128:131], v68 offset:704
    ds_read_b128 v[116:119], v68 offset:224
    ds_read_b128 v[132:135], v68 offset:736
    s_waitcnt lgkmcnt(8)
    v_pk_fma_f32 v[32:33], v[72:73], v[70:71], v[32:33] neg_lo:[1,0,0] neg_hi:[1,0,0]
    v_pk_fma_f32 v[34:35], v[74:75], v[70:71], v[34:35] neg_lo:[1,0,0] neg_hi:[1,0,0]
    v_pk_fma_f32 v[36:37], v[76:77], v[70:71], v[36:37] neg_lo:[1,0,0] neg_hi:[1,0,0]
    v_pk_fma_f32 v[38:39], v[78:79], v[70:71], v[38:39] neg_lo:[1,0,0] neg_hi:[1,0,0]
    v_pk_fma_f32 v[40:41], v[80:81], v[70:71], v[40:41] neg_lo:[1,0,0] neg_hi:[1,0,0]
    v_pk_fma_f32 v[42:43], v[82:83], v[70:71], v[42:43] neg_lo:[1,0,0] neg_hi:[1,0,0]
    v_pk_fma_f32 v[44:45], v[84:85], v[70:71], v[44:45] neg_lo:[1,0,0] neg_hi:[1,0,0]
    v_pk_fma_f32 v[46:47], v[86:87], v[70:71], v[46:47] neg_lo:[1,0,0] neg_hi:[1,0,0]
    v_pk_mul_f32 v[32:33], v[32:33], v[88:89]
    v_pk_mul_f32 v[34:35], v[34:35], v[90:91]
    v_pk_mul_f32 v[36:37], v[36:37], v[92:93]
    v_pk_mul_f32 v[38:39], v[38:39], v[94:95]
    v_pk_mul_f32 v[40:41], v[40:41], v[96:97]
    v_pk_mul_f32 v[42:43], v[42:43], v[98:99]
    v_pk_mul_f32 v[44:45], v[44:45], v[100:101]
    v_pk_mul_f32 v[46:47], v[46:47], v[102:103]
    v_cvt_pk_bf16_f32 v144, v32, v33
    v_cvt_pk_bf16_f32 v145, v34, v35
    v_cvt_pk_bf16_f32 v146, v36, v37
    v_cvt_pk_bf16_f32 v147, v38, v39
    v_cvt_pk_bf16_f32 v148, v40, v41
    v_cvt_pk_bf16_f32 v149, v42, v43
    v_cvt_pk_bf16_f32 v150, v44, v45
    v_cvt_pk_bf16_f32 v151, v46, v47
    v_permlane32_swap_b32 v144, v146
    v_permlane32_swap_b32 v145, v147
    v_permlane32_swap_b32 v148, v150
    v_permlane32_swap_b32 v149, v151
    buffer_store_dwordx4 v[144:147], v66, s[20:23], s42 offen offset:0
    buffer_store_dwordx4 v[148:151], v66, s[20:23], s42 offen offset:512
    s_waitcnt lgkmcnt(0)
    v_pk_fma_f32 v[48:49], v[104:105], v[70:71], v[48:49] neg_lo:[1,0,0] neg_hi:[1,0,0]
    v_pk_fma_f32 v[50:51], v[106:107], v[70:71], v[50:51] neg_lo:[1,0,0] neg_hi:[1,0,0]
    v_pk_fma_f32 v[52:53], v[108:109], v[70:71], v[52:53] neg_lo:[1,0,0] neg_hi:[1,0,0]
    v_pk_fma_f32 v[54:55], v[110:111], v[70:71], v[54:55] neg_lo:[1,0,0] neg_hi:[1,0,0]
    v_pk_fma_f32 v[56:57], v[112:113], v[70:71], v[56:57] neg_lo:[1,0,0] neg_hi:[1,0,0]
    v_pk_fma_f32 v[58:59], v[114:115], v[70:71], v[58:59] neg_lo:[1,0,0] neg_hi:[1,0,0]
    v_pk_fma_f32 v[60:61], v[116:117], v[70:71], v[60:61] neg_lo:[1,0,0] neg_hi:[1,0,0]
    v_pk_fma_f32 v[62:63], v[118:119], v[70:71], v[62:63] neg_lo:[1,0,0] neg_hi:[1,0,0]
    v_pk_mul_f32 v[48:49], v[48:49], v[120:121]
    v_pk_mul_f32 v[50:51], v[50:51], v[122:123]
    v_pk_mul_f32 v[52:53], v[52:53], v[124:125]
    v_pk_mul_f32 v[54:55], v[54:55], v[126:127]
    v_pk_mul_f32 v[56:57], v[56:57], v[128:129]
    v_pk_mul_f32 v[58:59], v[58:59], v[130:131]
    v_pk_mul_f32 v[60:61], v[60:61], v[132:133]
    v_pk_mul_f32 v[62:63], v[62:63], v[134:135]
    v_cvt_pk_bf16_f32 v192, v48, v49
    v_cvt_pk_bf16_f32 v193, v50, v51
    v_cvt_pk_bf16_f32 v194, v52, v53
    v_cvt_pk_bf16_f32 v195, v54, v55
    v_cvt_pk_bf16_f32 v196, v56, v57
    v_cvt_pk_bf16_f32 v197, v58, v59
    v_cvt_pk_bf16_f32 v198, v60, v61
    v_cvt_pk_bf16_f32 v199, v62, v63
    v_permlane32_swap_b32 v192, v194
    v_permlane32_swap_b32 v193, v195
    v_permlane32_swap_b32 v196, v198
    v_permlane32_swap_b32 v197, v199
    buffer_store_dwordx4 v[192:195], v66, s[20:23], s42 offen offset:1024
    buffer_store_dwordx4 v[196:199], v66, s[20:23], s42 offen offset:1536
k1_done:
    s_endpgm
.globl k2_kernel
.p2align 8
.type k2_kernel,@function
k2_kernel:
    s_cmp_ge_u32 s2, 256
    s_cbranch_scc1 k2_done
    s_load_dwordx4 s[4:7], s[0:1], 0
    s_load_dwordx2 s[8:9], s[0:1], 32
    s_load_dwordx2 s[10:11], s[0:1], 80
    v_lshrrev_b32 v2, 6, v0
    s_nop 0
    v_readfirstlane_b32 s28, v2
    s_cmp_ge_u32 s2, 240
    s_cbranch_scc1 k2_wt
    s_cmp_ge_u32 s2, 208
    s_cbranch_scc1 k2_kv
    s_cmp_ge_u32 s2, 176
    s_cbranch_scc1 k2_ln
    s_and_b32 s33, s2, 7
    s_lshr_b32 s34, s2, 3
    s_lshl_b32 s24, s33, 1
    s_cmp_ge_u32 s34, 11
    s_cselect_b32 s41, 1, 0
    s_cselect_b32 s25, 11, 0
    s_add_u32 s24, s24, s41
    s_sub_u32 s25, s34, s25
    s_and_b32 s40, s25, 7
    s_lshr_b32 s29, s28, 2
    s_and_b32 s30, s28, 3
    s_movk_i32 s26, 3840
    s_mov_b32 s18, 2457600
    s_cmp_lt_u32 s25, 5
    s_cselect_b32 s26, s26, 3072
    s_cselect_b32 s18, s18, 1966080
    s_cselect_b32 s33, 0, -1280
    s_lshl_b32 s27, s25, 8
    s_add_i32 s27, s27, s33
    s_mov_b32 s19, 0x00020000
    s_lshl_b32 s35, s28, 11
    s_lshl_b32 s38, s26, 6
    s_lshr_b32 s32, s2, 3
    s_mul_i32 s33, s32, 6554
    s_lshr_b32 s33, s33, 16
    s_mul_i32 s33, s33, 10
    s_sub_u32 s32, s32, s33
    v_and_b32 v1, 63, v0
    v_lshrrev_b32 v5, 3, v1
    s_lshl_b32 s33, s24, 7
    s_lshl_b32 s34, s28, 4
    s_add_u32 s33, s33, s34
    v_add_u32 v5, s33, v5
    s_movk_i32 s34, 1280
    v_mul_lo_u32 v5, v5, s34
    v_lshrrev_b32 v6, 4, v1
    v_and_b32 v7, 7, v1
    v_xor_b32 v8, v7, v6
    v_lshlrev_b32 v8, 4, v8
    v_add_u32 v176, v5, v8
    v_add_u32 v6, 4, v6
    v_xor_b32 v8, v7, v6
    v_lshlrev_b32 v8, 4, v8
    v_add_u32 v8, v5, v8
    v_add_u32 v177, 9216, v8
    v_lshrrev_b32 v6, 4, v1
    s_lshl_b32 s33, s28, 3
    v_add_u32 v5, s33, v6
    v_mul_lo_u32 v5, v5, s26
    v_and_b32 v7, 15, v1
    v_lshrrev_b32 v7, 2, v7
    v_xor_b32 v7, v7, v6
    v_lshlrev_b32 v7, 2, v7
    v_and_b32 v8, 3, v1
    v_add_u32 v7, v7, v8
    v_lshlrev_b32 v7, 4, v7
    v_add_u32 v5, v5, v7
    v_add_u32 v178, s27, v5
    s_lshl_b32 s33, s26, 2
    s_sub_u32 s33, s33, 1024
    v_add_u32 v179, s33, v178
    s_waitcnt lgkmcnt(0)
    s_cmp_lt_u32 s25, 5
    s_cselect_b32 s16, s6, s8
    s_cselect_b32 s17, s7, s9
    s_and_b32 s17, s17, 0xffff
    s_mov_b32 s12, s4
    s_and_b32 s13, s5, 0xffff
    s_mov_b32 s14, 2621440
    s_mov_b32 s15, 0x00020000
    s_add_u32 s48, s32, 0
    s_sub_u32 s49, s48, 10
    s_cmp_ge_u32 s48, 10
    s_cselect_b32 s48, s49, s48
    s_add_u32 m0, s35, 0
    s_lshl_b32 s36, s48, 7
    buffer_load_dwordx4 v176, s[12:15], s36 offen lds
    buffer_load_dwordx4 v177, s[12:15], s36 offen offset:1024 lds
    s_add_u32 m0, s35, 16384
    s_mul_i32 s37, s38, s48
    buffer_load_dwordx4 v178, s[16:19], s37 offen lds
    buffer_load_dwordx4 v179, s[16:19], s37 offen offset:1024 lds
    s_add_u32 s48, s32, 1
    s_sub_u32 s49, s48, 10
    s_cmp_ge_u32 s48, 10
    s_cselect_b32 s48, s49, s48
    s_add_u32 m0, s35, 32768
    s_lshl_b32 s36, s48, 7
    buffer_load_dwordx4 v176, s[12:15], s36 offen lds
    buffer_load_dwordx4 v177, s[12:15], s36 offen offset:1024 lds
    s_add_u32 m0, s35, 49152
    s_mul_i32 s37, s38, s48
    buffer_load_dwordx4 v178, s[16:19], s37 offen lds
    buffer_load_dwordx4 v179, s[16:19], s37 offen offset:1024 lds
    s_mov_b32 s20, s10
    s_and_b32 s21, s11, 0xffff
    s_mov_b32 s22, 25182208
    s_mov_b32 s23, 0x00020000
    v_and_b32 v2, 31, v1
    v_lshrrev_b32 v3, 5, v1
    v_lshrrev_b32 v4, 1, v1
    v_and_b32 v4, 7, v4
    v_xor_b32 v4, v3, v4
    v_lshlrev_b32 v4, 4, v4
    v_lshlrev_b32 v5, 7, v2
    v_add_u32 v4, v4, v5
    s_lshl_b32 s33, s29, 13
    v_add_u32 v4, s33, v4
    s_xor_b32 s31, s30, s29
    s_lshl_b32 s33, s31, 5
    v_xor_b32 v4, s33, v4
    v_xor_b32 v160, 0, v4
    v_add_u32 v164, 0x10000, v160
    v_xor_b32 v161, 32, v4
    v_add_u32 v165, 0x10000, v161
    v_xor_b32 v162, 64, v4
    v_add_u32 v166, 0x10000, v162
    v_xor_b32 v163, 96, v4
    v_add_u32 v167, 0x10000, v163
    v_and_b32 v5, 15, v1
    v_lshrrev_b32 v5, 2, v5
    v_and_b32 v6, 3, v1
    v_lshlrev_b32 v7, 3, v3
    v_add_u32 v7, v7, v5
    v_lshlrev_b32 v7, 8, v7
    v_xor_b32 v8, s30, v5
    v_lshlrev_b32 v8, 6, v8
    v_add_u32 v7, v7, v8
    v_lshrrev_b32 v8, 4, v1
    v_and_b32 v8, 1, v8
    v_lshlrev_b32 v8, 5, v8
    v_add_u32 v7, v7, v8
    v_lshlrev_b32 v6, 3, v6
    v_add_u32 v7, v7, v6
    s_lshl_b32 s33, s31, 12
    s_add_u32 s33, s33, 0x4000
    s_xor_b32 s34, s33, 0
    v_add_u32 v168, s34, v7
    v_add_u32 v172, 0x10000, v168
    s_xor_b32 s34, s33, 4096
    v_add_u32 v169, s34, v7
    v_add_u32 v173, 0x10000, v169
    s_xor_b32 s34, s33, 8192
    v_add_u32 v170, s34, v7
    v_add_u32 v174, 0x10000, v170
    s_xor_b32 s34, s33, 12288
    v_add_u32 v171, s34, v7
    v_add_u32 v175, 0x10000, v171
    s_lshl_b32 s33, s24, 10
    s_lshl_b32 s34, s29, 9
    s_add_u32 s33, s33, s34
    s_add_u32 s33, s33, 25165824
    v_lshlrev_b32 v4, 3, v2
    buffer_load_dwordx2 v[202:203], v4, s[20:23], s33 offen
    buffer_load_dwordx2 v[204:205], v4, s[20:23], s33 offen offset:256
    v_mov_b32 v240, 0x3f800000
    v_mov_b32 v241, 0x3f800000
    v_mov_b32 v242, 0x3fb8aa3b
    v_mov_b32 v243, 0x3fb8aa3b
    v_mov_b32 v244, 0x358637bd
    v_mov_b32 v245, 0x358637bd
    v_mov_b32 v246, 0x3d372713
    v_mov_b32 v247, 0x3d372713
    v_mov_b32 v248, 0xc0135761
    v_mov_b32 v249, 0xc0135761
    v_mov_b32 v200, 0x3f803f80
    v_mov_b32 v201, 0x3f803f80
    s_waitcnt vmcnt(6)
    s_barrier
    ds_read_b128 v[64:67], v160 offset:0
    ds_read_b64_tr_b16 v[72:73], v168 offset:0
    ds_read_b64_tr_b16 v[74:75], v168 offset:1024
    ds_read_b128 v[68:71], v160 offset:4096
    ds_read_b128 v[76:79], v161 offset:0
    ds_read_b64_tr_b16 v[84:85], v169 offset:0
    ds_read_b64_tr_b16 v[86:87], v169 offset:1024
    ds_read_b128 v[80:83], v161 offset:4096
    ds_read_b128 v[88:91], v162 offset:0
    ds_read_b64_tr_b16 v[96:97], v170 offset:0
    ds_read_b64_tr_b16 v[98:99], v170 offset:1024
    ds_read_b128 v[92:95], v162 offset:4096
    ds_read_b128 v[100:103], v163 offset:0
    ds_read_b64_tr_b16 v[108:109], v171 offset:0
    ds_read_b64_tr_b16 v[110:111], v171 offset:1024
    ds_read_b128 v[104:107], v163 offset:4096
    s_waitcnt lgkmcnt(0)
    s_waitcnt vmcnt(2)
    s_barrier
    v_mfma_f32_32x32x16_bf16 v[32:47], v[72:75], v[64:67], 0
    ds_read_b128 v[112:115], v160 offset:32768
    ds_read_b64_tr_b16 v[120:121], v168 offset:32768
    s_add_u32 s48, s32, 2
    s_sub_u32 s49, s48, 10
    s_cmp_ge_u32 s48, 10
    s_cselect_b32 s48, s49, s48
    s_add_u32 m0, s35, 65536
    s_lshl_b32 s36, s48, 7
    buffer_load_dwordx4 v176, s[12:15], s36 offen lds
    buffer_load_dwordx4 v177, s[12:15], s36 offen offset:1024 lds
    v_mfma_f32_4x4x4_16b_bf16 v[196:199], v[72:73], v[200:201], 0
    v_mfma_f32_32x32x16_bf16 v[48:63], v[72:75], v[68:71], 0
    ds_read_b64_tr_b16 v[122:123], v168 offset:33792
    ds_read_b128 v[116:119], v160 offset:36864
    v_mfma_f32_4x4x4_16b_bf16 v[196:199], v[96:97], v[200:201], v[196:199]
    v_mfma_f32_32x32x16_bf16 v[32:47], v[84:87], v[76:79], v[32:47]
    ds_read_b128 v[124:127], v161 offset:32768
    ds_read_b64_tr_b16 v[132:133], v169 offset:32768
    s_add_u32 m0, s35, 81920
    s_mul_i32 s37, s38, s48
    buffer_load_dwordx4 v178, s[16:19], s37 offen lds
    buffer_load_dwordx4 v179, s[16:19], s37 offen offset:1024 lds
    v_mfma_f32_4x4x4_16b_bf16 v[196:199], v[74:75], v[200:201], v[196:199]
    v_mfma_f32_32x32x16_bf16 v[48:63], v[84:87], v[80:83], v[48:63]
    ds_read_b64_tr_b16 v[134:135], v169 offset:33792
    ds_read_b128 v[128:131], v161 offset:36864
    v_mfma_f32_4x4x4_16b_bf16 v[196:199], v[98:99], v[200:201], v[196:199]
    v_mfma_f32_32x32x16_bf16 v[32:47], v[96:99], v[88:91], v[32:47]
    ds_read_b128 v[136:139], v162 offset:32768
    ds_read_b64_tr_b16 v[144:145], v170 offset:32768
    s_add_u32 s48, s32, 3
    s_sub_u32 s49, s48, 10
    s_cmp_ge_u32 s48, 10
    s_cselect_b32 s48, s49, s48
    s_add_u32 m0, s35, 98304
    s_lshl_b32 s36, s48, 7
    buffer_load_dwordx4 v176, s[12:15], s36 offen lds
    buffer_load_dwordx4 v177, s[12:15], s36 offen offset:1024 lds
    v_mfma_f32_32x32x16_bf16 v[48:63], v[96:99], v[92:95], v[48:63]
    ds_read_b64_tr_b16 v[146:147], v170 offset:33792
    ds_read_b128 v[140:143], v162 offset:36864
    v_mfma_f32_32x32x16_bf16 v[32:47], v[108:111], v[100:103], v[32:47]
    ds_read_b128 v[148:151], v163 offset:32768
    ds_read_b64_tr_b16 v[156:157], v171 offset:32768
    s_add_u32 m0, s35, 114688
    s_mul_i32 s37, s38, s48
    buffer_load_dwordx4 v178, s[16:19], s37 offen lds
    buffer_load_dwordx4 v179, s[16:19], s37 offen offset:1024 lds
    v_mfma_f32_32x32x16_bf16 v[48:63], v[108:111], v[104:107], v[48:63]
    ds_read_b64_tr_b16 v[158:159], v171 offset:33792
    ds_read_b128 v[152:155], v163 offset:36864
    s_waitcnt lgkmcnt(0)
    s_waitcnt vmcnt(4)
    s_barrier
    v_mfma_f32_32x32x16_bf16 v[32:47], v[120:123], v[112:115], v[32:47]
    ds_read_b128 v[64:67], v164 offset:0
    ds_read_b64_tr_b16 v[72:73], v172 offset:0
    s_add_u32 s48, s32, 4
    s_sub_u32 s49, s48, 10
    s_cmp_ge_u32 s48, 10
    s_cselect_b32 s48, s49, s48
    s_add_u32 m0, s35, 0
    s_lshl_b32 s36, s48, 7
    buffer_load_dwordx4 v176, s[12:15], s36 offen lds
    buffer_load_dwordx4 v177, s[12:15], s36 offen offset:1024 lds
    v_mfma_f32_4x4x4_16b_bf16 v[196:199], v[120:121], v[200:201], v[196:199]
    v_mfma_f32_32x32x16_bf16 v[48:63], v[120:123], v[116:119], v[48:63]
    ds_read_b64_tr_b16 v[74:75], v172 offset:1024
    ds_read_b128 v[68:71], v164 offset:4096
    v_mfma_f32_4x4x4_16b_bf16 v[196:199], v[144:145], v[200:201], v[196:199]
    v_mfma_f32_32x32x16_bf16 v[32:47], v[132:135], v[124:127], v[32:47]
    ds_read_b128 v[76:79], v165 offset:0
    ds_read_b64_tr_b16 v[84:85], v173 offset:0
    s_add_u32 m0, s35, 16384
    s_mul_i32 s37, s38, s48
    buffer_load_dwordx4 v178, s[16:19], s37 offen lds
    buffer_load_dwordx4 v179, s[16:19], s37 offen offset:1024 lds
    v_mfma_f32_4x4x4_16b_bf16 v[196:199], v[122:123], v[200:201], v[196:199]
    v_mfma_f32_32x32x16_bf16 v[48:63], v[132:135], v[128:131], v[48:63]
    ds_read_b64_tr_b16 v[86:87], v173 offset:1024
    ds_read_b128 v[80:83], v165 offset:4096
    v_mfma_f32_4x4x4_16b_bf16 v[196:199], v[146:147], v[200:201], v[196:199]
    v_mfma_f32_32x32x16_bf16 v[32:47], v[144:147], v[136:139], v[32:47]
    ds_read_b128 v[88:91], v166 offset:0
    ds_read_b64_tr_b16 v[96:97], v174 offset:0
    v_mfma_f32_32x32x16_bf16 v[48:63], v[144:147], v[140:143], v[48:63]
    ds_read_b64_tr_b16 v[98:99], v174 offset:1024
    ds_read_b128 v[92:95], v166 offset:4096
    v_mfma_f32_32x32x16_bf16 v[32:47], v[156:159], v[148:151], v[32:47]
    ds_read_b128 v[100:103], v167 offset:0
    ds_read_b64_tr_b16 v[108:109], v175 offset:0
    v_mfma_f32_32x32x16_bf16 v[48:63], v[156:159], v[152:155], v[48:63]
    ds_read_b64_tr_b16 v[110:111], v175 offset:1024
    ds_read_b128 v[104:107], v167 offset:4096
    s_waitcnt lgkmcnt(0)
    s_waitcnt vmcnt(4)
    s_barrier
    v_mfma_f32_32x32x16_bf16 v[32:47], v[72:75], v[64:67], v[32:47]
    ds_read_b128 v[112:115], v164 offset:32768
    ds_read_b64_tr_b16 v[120:121], v172 offset:32768
    s_add_u32 s48, s32, 5
    s_sub_u32 s49, s48, 10
    s_cmp_ge_u32 s48, 10
    s_cselect_b32 s48, s49, s48
    s_add_u32 m0, s35, 32768
    s_lshl_b32 s36, s48, 7
    buffer_load_dwordx4 v176, s[12:15], s36 offen lds
    buffer_load_dwordx4 v177, s[12:15], s36 offen offset:1024 lds
    v_mfma_f32_4x4x4_16b_bf16 v[196:199], v[72:73], v[200:201], v[196:199]
    v_mfma_f32_32x32x16_bf16 v[48:63], v[72:75], v[68:71], v[48:63]
    ds_read_b64_tr_b16 v[122:123], v172 offset:33792
    ds_read_b128 v[116:119], v164 offset:36864
    v_mfma_f32_4x4x4_16b_bf16 v[196:199], v[96:97], v[200:201], v[196:199]
    v_mfma_f32_32x32x16_bf16 v[32:47], v[84:87], v[76:79], v[32:47]
    ds_read_b128 v[124:127], v165 offset:32768
    ds_read_b64_tr_b16 v[132:133], v173 offset:32768
    s_add_u32 m0, s35, 49152
    s_mul_i32 s37, s38, s48
    buffer_load_dwordx4 v178, s[16:19], s37 offen lds
    buffer_load_dwordx4 v179, s[16:19], s37 offen offset:1024 lds
    v_mfma_f32_4x4x4_16b_bf16 v[196:199], v[74:75], v[200:201], v[196:199]
    v_mfma_f32_32x32x16_bf16 v[48:63], v[84:87], v[80:83], v[48:63]
    ds_read_b64_tr_b16 v[134:135], v173 offset:33792
    ds_read_b128 v[128:131], v165 offset:36864
    v_mfma_f32_4x4x4_16b_bf16 v[196:199], v[98:99], v[200:201], v[196:199]
    v_mfma_f32_32x32x16_bf16 v[32:47], v[96:99], v[88:91], v[32:47]
    ds_read_b128 v[136:139], v166 offset:32768
    ds_read_b64_tr_b16 v[144:145], v174 offset:32768
    v_mfma_f32_32x32x16_bf16 v[48:63], v[96:99], v[92:95], v[48:63]
    ds_read_b64_tr_b16 v[146:147], v174 offset:33792
    ds_read_b128 v[140:143], v166 offset:36864
    v_mfma_f32_32x32x16_bf16 v[32:47], v[108:111], v[100:103], v[32:47]
    ds_read_b128 v[148:151], v167 offset:32768
    ds_read_b64_tr_b16 v[156:157], v175 offset:32768
    v_mfma_f32_32x32x16_bf16 v[48:63], v[108:111], v[104:107], v[48:63]
    ds_read_b64_tr_b16 v[158:159], v175 offset:33792
    ds_read_b128 v[152:155], v167 offset:36864
    s_waitcnt lgkmcnt(0)
    s_waitcnt vmcnt(4)
    s_barrier
    v_mfma_f32_32x32x16_bf16 v[32:47], v[120:123], v[112:115], v[32:47]
    ds_read_b128 v[64:67], v160 offset:0
    ds_read_b64_tr_b16 v[72:73], v168 offset:0
    s_add_u32 s48, s32, 6
    s_sub_u32 s49, s48, 10
    s_cmp_ge_u32 s48, 10
    s_cselect_b32 s48, s49, s48
    s_add_u32 m0, s35, 65536
    s_lshl_b32 s36, s48, 7
    buffer_load_dwordx4 v176, s[12:15], s36 offen lds
    buffer_load_dwordx4 v177, s[12:15], s36 offen offset:1024 lds
    v_mfma_f32_4x4x4_16b_bf16 v[196:199], v[120:121], v[200:201], v[196:199]
    v_mfma_f32_32x32x16_bf16 v[48:63], v[120:123], v[116:119], v[48:63]
    ds_read_b64_tr_b16 v[74:75], v168 offset:1024
    ds_read_b128 v[68:71], v160 offset:4096
    v_mfma_f32_4x4x4_16b_bf16 v[196:199], v[144:145], v[200:201], v[196:199]
    v_mfma_f32_32x32x16_bf16 v[32:47], v[132:135], v[124:127], v[32:47]
    ds_read_b128 v[76:79], v161 offset:0
    ds_read_b64_tr_b16 v[84:85], v169 offset:0
    s_add_u32 m0, s35, 81920
    s_mul_i32 s37, s38, s48
    buffer_load_dwordx4 v178, s[16:19], s37 offen lds
    buffer_load_dwordx4 v179, s[16:19], s37 offen offset:1024 lds
    v_mfma_f32_4x4x4_16b_bf16 v[196:199], v[122:123], v[200:201], v[196:199]
    v_mfma_f32_32x32x16_bf16 v[48:63], v[132:135], v[128:131], v[48:63]
    ds_read_b64_tr_b16 v[86:87], v169 offset:1024
    ds_read_b128 v[80:83], v161 offset:4096
    v_mfma_f32_4x4x4_16b_bf16 v[196:199], v[146:147], v[200:201], v[196:199]
    v_mfma_f32_32x32x16_bf16 v[32:47], v[144:147], v[136:139], v[32:47]
    ds_read_b128 v[88:91], v162 offset:0
    ds_read_b64_tr_b16 v[96:97], v170 offset:0
    v_mfma_f32_32x32x16_bf16 v[48:63], v[144:147], v[140:143], v[48:63]
    ds_read_b64_tr_b16 v[98:99], v170 offset:1024
    ds_read_b128 v[92:95], v162 offset:4096
    v_mfma_f32_32x32x16_bf16 v[32:47], v[156:159], v[148:151], v[32:47]
    ds_read_b128 v[100:103], v163 offset:0
    ds_read_b64_tr_b16 v[108:109], v171 offset:0
    v_mfma_f32_32x32x16_bf16 v[48:63], v[156:159], v[152:155], v[48:63]
    ds_read_b64_tr_b16 v[110:111], v171 offset:1024
    ds_read_b128 v[104:107], v163 offset:4096
    s_waitcnt lgkmcnt(0)
    s_waitcnt vmcnt(4)
    s_barrier
    v_mfma_f32_32x32x16_bf16 v[32:47], v[72:75], v[64:67], v[32:47]
    ds_read_b128 v[112:115], v160 offset:32768
    ds_read_b64_tr_b16 v[120:121], v168 offset:32768
    s_add_u32 s48, s32, 7
    s_sub_u32 s49, s48, 10
    s_cmp_ge_u32 s48, 10
    s_cselect_b32 s48, s49, s48
    s_add_u32 m0, s35, 98304
    s_lshl_b32 s36, s48, 7
    buffer_load_dwordx4 v176, s[12:15], s36 offen lds
    buffer_load_dwordx4 v177, s[12:15], s36 offen offset:1024 lds
    v_mfma_f32_4x4x4_16b_bf16 v[196:199], v[72:73], v[200:201], v[196:199]
    v_mfma_f32_32x32x16_bf16 v[48:63], v[72:75], v[68:71], v[48:63]
    ds_read_b64_tr_b16 v[122:123], v168 offset:33792
    ds_read_b128 v[116:119], v160 offset:36864
    v_mfma_f32_4x4x4_16b_bf16 v[196:199], v[96:97], v[200:201], v[196:199]
    v_mfma_f32_32x32x16_bf16 v[32:47], v[84:87], v[76:79], v[32:47]
    ds_read_b128 v[124:127], v161 offset:32768
    ds_read_b64_tr_b16 v[132:133], v169 offset:32768
    s_add_u32 m0, s35, 114688
    s_mul_i32 s37, s38, s48
    buffer_load_dwordx4 v178, s[16:19], s37 offen lds
    buffer_load_dwordx4 v179, s[16:19], s37 offen offset:1024 lds
    v_mfma_f32_4x4x4_16b_bf16 v[196:199], v[74:75], v[200:201], v[196:199]
    v_mfma_f32_32x32x16_bf16 v[48:63], v[84:87], v[80:83], v[48:63]
    ds_read_b64_tr_b16 v[134:135], v169 offset:33792
    ds_read_b128 v[128:131], v161 offset:36864
    v_mfma_f32_4x4x4_16b_bf16 v[196:199], v[98:99], v[200:201], v[196:199]
    v_mfma_f32_32x32x16_bf16 v[32:47], v[96:99], v[88:91], v[32:47]
    ds_read_b128 v[136:139], v162 offset:32768
    ds_read_b64_tr_b16 v[144:145], v170 offset:32768
    v_mfma_f32_32x32x16_bf16 v[48:63], v[96:99], v[92:95], v[48:63]
    ds_read_b64_tr_b16 v[146:147], v170 offset:33792
    ds_read_b128 v[140:143], v162 offset:36864
    v_mfma_f32_32x32x16_bf16 v[32:47], v[108:111], v[100:103], v[32:47]
    ds_read_b128 v[148:151], v163 offset:32768
    ds_read_b64_tr_b16 v[156:157], v171 offset:32768
    v_mfma_f32_32x32x16_bf16 v[48:63], v[108:111], v[104:107], v[48:63]
    ds_read_b64_tr_b16 v[158:159], v171 offset:33792
    ds_read_b128 v[152:155], v163 offset:36864
    s_waitcnt lgkmcnt(0)
    s_waitcnt vmcnt(4)
    s_barrier
    v_mfma_f32_32x32x16_bf16 v[32:47], v[120:123], v[112:115], v[32:47]
    ds_read_b128 v[64:67], v164 offset:0
    ds_read_b64_tr_b16 v[72:73], v172 offset:0
    s_add_u32 s48, s32, 8
    s_sub_u32 s49, s48, 10
    s_cmp_ge_u32 s48, 10
    s_cselect_b32 s48, s49, s48
    s_add_u32 m0, s35, 0
    s_lshl_b32 s36, s48, 7
    buffer_load_dwordx4 v176, s[12:15], s36 offen lds
    buffer_load_dwordx4 v177, s[12:15], s36 offen offset:1024 lds
    v_mfma_f32_4x4x4_16b_bf16 v[196:199], v[120:121], v[200:201], v[196:199]
    v_mfma_f32_32x32x16_bf16 v[48:63], v[120:123], v[116:119], v[48:63]
    ds_read_b64_tr_b16 v[74:75], v172 offset:1024
    ds_read_b128 v[68:71], v164 offset:4096
    v_mfma_f32_4x4x4_16b_bf16 v[196:199], v[144:145], v[200:201], v[196:199]
    v_mfma_f32_32x32x16_bf16 v[32:47], v[132:135], v[124:127], v[32:47]
    ds_read_b128 v[76:79], v165 offset:0
    ds_read_b64_tr_b16 v[84:85], v173 offset:0
    s_add_u32 m0, s35, 16384
    s_mul_i32 s37, s38, s48
    buffer_load_dwordx4 v178, s[16:19], s37 offen lds
    buffer_load_dwordx4 v179, s[16:19], s37 offen offset:1024 lds
    v_mfma_f32_4x4x4_16b_bf16 v[196:199], v[122:123], v[200:201], v[196:199]
    v_mfma_f32_32x32x16_bf16 v[48:63], v[132:135], v[128:131], v[48:63]
    ds_read_b64_tr_b16 v[86:87], v173 offset:1024
    ds_read_b128 v[80:83], v165 offset:4096
    v_mfma_f32_4x4x4_16b_bf16 v[196:199], v[146:147], v[200:201], v[196:199]
    v_mfma_f32_32x32x16_bf16 v[32:47], v[144:147], v[136:139], v[32:47]
    ds_read_b128 v[88:91], v166 offset:0
    ds_read_b64_tr_b16 v[96:97], v174 offset:0
    v_mfma_f32_32x32x16_bf16 v[48:63], v[144:147], v[140:143], v[48:63]
    ds_read_b64_tr_b16 v[98:99], v174 offset:1024
    ds_read_b128 v[92:95], v166 offset:4096
    v_mfma_f32_32x32x16_bf16 v[32:47], v[156:159], v[148:151], v[32:47]
    ds_read_b128 v[100:103], v167 offset:0
    ds_read_b64_tr_b16 v[108:109], v175 offset:0
    v_mfma_f32_32x32x16_bf16 v[48:63], v[156:159], v[152:155], v[48:63]
    ds_read_b64_tr_b16 v[110:111], v175 offset:1024
    ds_read_b128 v[104:107], v167 offset:4096
    s_waitcnt lgkmcnt(0)
    s_waitcnt vmcnt(4)
    s_barrier
    v_mfma_f32_32x32x16_bf16 v[32:47], v[72:75], v[64:67], v[32:47]
    ds_read_b128 v[112:115], v164 offset:32768
    ds_read_b64_tr_b16 v[120:121], v172 offset:32768
    s_add_u32 s48, s32, 9
    s_sub_u32 s49, s48, 10
    s_cmp_ge_u32 s48, 10
    s_cselect_b32 s48, s49, s48
    s_add_u32 m0, s35, 32768
    s_lshl_b32 s36, s48, 7
    buffer_load_dwordx4 v176, s[12:15], s36 offen lds
    buffer_load_dwordx4 v177, s[12:15], s36 offen offset:1024 lds
    v_mfma_f32_4x4x4_16b_bf16 v[196:199], v[72:73], v[200:201], v[196:199]
    v_mfma_f32_32x32x16_bf16 v[48:63], v[72:75], v[68:71], v[48:63]
    ds_read_b64_tr_b16 v[122:123], v172 offset:33792
    ds_read_b128 v[116:119], v164 offset:36864
    v_mfma_f32_4x4x4_16b_bf16 v[196:199], v[96:97], v[200:201], v[196:199]
    v_mfma_f32_32x32x16_bf16 v[32:47], v[84:87], v[76:79], v[32:47]
    ds_read_b128 v[124:127], v165 offset:32768
    ds_read_b64_tr_b16 v[132:133], v173 offset:32768
    s_add_u32 m0, s35, 49152
    s_mul_i32 s37, s38, s48
    buffer_load_dwordx4 v178, s[16:19], s37 offen lds
    buffer_load_dwordx4 v179, s[16:19], s37 offen offset:1024 lds
    v_mfma_f32_4x4x4_16b_bf16 v[196:199], v[74:75], v[200:201], v[196:199]
    v_mfma_f32_32x32x16_bf16 v[48:63], v[84:87], v[80:83], v[48:63]
    ds_read_b64_tr_b16 v[134:135], v173 offset:33792
    ds_read_b128 v[128:131], v165 offset:36864
    v_mfma_f32_4x4x4_16b_bf16 v[196:199], v[98:99], v[200:201], v[196:199]
    v_mfma_f32_32x32x16_bf16 v[32:47], v[96:99], v[88:91], v[32:47]
    ds_read_b128 v[136:139], v166 offset:32768
    ds_read_b64_tr_b16 v[144:145], v174 offset:32768
    v_mfma_f32_32x32x16_bf16 v[48:63], v[96:99], v[92:95], v[48:63]
    ds_read_b64_tr_b16 v[146:147], v174 offset:33792
    ds_read_b128 v[140:143], v166 offset:36864
    s_load_dwordx2 s[44:45], s[0:1], 40
    s_and_b32 s42, s2, 7
    s_lshr_b32 s42, s42, 1
    s_lshl_b32 s42, s42, 21
    s_lshr_b32 s43, s2, 3
    s_lshl_b32 s43, s43, 3
    s_add_u32 s43, s43, s28
    s_mul_i32 s43, s43, 12288
    s_add_u32 s42, s42, s43
    v_lshlrev_b32 v5, 7, v1
    s_mov_b32 s46, 8388608
    s_mov_b32 s47, 0x00020000
    v_mfma_f32_32x32x16_bf16 v[32:47], v[108:111], v[100:103], v[32:47]
    ds_read_b128 v[148:151], v167 offset:32768
    ds_read_b64_tr_b16 v[156:157], v175 offset:32768
    v_mfma_f32_32x32x16_bf16 v[48:63], v[108:111], v[104:107], v[48:63]
    ds_read_b64_tr_b16 v[158:159], v175 offset:33792
    ds_read_b128 v[152:155], v167 offset:36864
    s_waitcnt lgkmcnt(0)
    s_waitcnt vmcnt(4)
    s_barrier
    v_mfma_f32_32x32x16_bf16 v[32:47], v[120:123], v[112:115], v[32:47]
    ds_read_b128 v[64:67], v160 offset:0
    ds_read_b64_tr_b16 v[72:73], v168 offset:0
    v_mfma_f32_4x4x4_16b_bf16 v[196:199], v[120:121], v[200:201], v[196:199]
    v_mfma_f32_32x32x16_bf16 v[48:63], v[120:123], v[116:119], v[48:63]
    ds_read_b64_tr_b16 v[74:75], v168 offset:1024
    ds_read_b128 v[68:71], v160 offset:4096
    v_mfma_f32_4x4x4_16b_bf16 v[196:199], v[144:145], v[200:201], v[196:199]
    v_mfma_f32_32x32x16_bf16 v[32:47], v[132:135], v[124:127], v[32:47]
    ds_read_b128 v[76:79], v161 offset:0
    ds_read_b64_tr_b16 v[84:85], v169 offset:0
    v_mfma_f32_4x4x4_16b_bf16 v[196:199], v[122:123], v[200:201], v[196:199]
    v_mfma_f32_32x32x16_bf16 v[48:63], v[132:135], v[128:131], v[48:63]
    ds_read_b64_tr_b16 v[86:87], v169 offset:1024
    ds_read_b128 v[80:83], v161 offset:4096
    v_mfma_f32_4x4x4_16b_bf16 v[196:199], v[146:147], v[200:201], v[196:199]
    v_mfma_f32_32x32x16_bf16 v[32:47], v[144:147], v[136:139], v[32:47]
    ds_read_b128 v[88:91], v162 offset:0
    ds_read_b64_tr_b16 v[96:97], v170 offset:0
    v_mfma_f32_32x32x16_bf16 v[48:63], v[144:147], v[140:143], v[48:63]
    ds_read_b64_tr_b16 v[98:99], v170 offset:1024
    ds_read_b128 v[92:95], v162 offset:4096
    s_and_b32 s45, s45, 0xffff
    s_add_u32 s43, s42, 8192
    buffer_load_dword v8, v5, s[44:47], s42 offen
    buffer_load_dword v8, v5, s[44:47], s43 offen
    v_mfma_f32_32x32x16_bf16 v[32:47], v[156:159], v[148:151], v[32:47]
    ds_read_b128 v[100:103], v163 offset:0
    ds_read_b64_tr_b16 v[108:109], v171 offset:0
    v_mfma_f32_32x32x16_bf16 v[48:63], v[156:159], v[152:155], v[48:63]
    ds_read_b64_tr_b16 v[110:111], v171 offset:1024
    ds_read_b128 v[104:107], v163 offset:4096
    s_waitcnt lgkmcnt(0)
    s_waitcnt vmcnt(2)
    s_barrier
    v_mfma_f32_32x32x16_bf16 v[32:47], v[72:75], v[64:67], v[32:47]
    ds_read_b128 v[112:115], v160 offset:32768
    ds_read_b64_tr_b16 v[120:121], v168 offset:32768
    v_mfma_f32_4x4x4_16b_bf16 v[196:199], v[72:73], v[200:201], v[196:199]
    v_mfma_f32_32x32x16_bf16 v[48:63], v[72:75], v[68:71], v[48:63]
    ds_read_b64_tr_b16 v[122:123], v168 offset:33792
    ds_read_b128 v[116:119], v160 offset:36864
    v_mfma_f32_4x4x4_16b_bf16 v[196:199], v[96:97], v[200:201], v[196:199]
    v_mfma_f32_32x32x16_bf16 v[32:47], v[84:87], v[76:79], v[32:47]
    ds_read_b128 v[124:127], v161 offset:32768
    ds_read_b64_tr_b16 v[132:133], v169 offset:32768
    v_mfma_f32_4x4x4_16b_bf16 v[196:199], v[74:75], v[200:201], v[196:199]
    v_mfma_f32_32x32x16_bf16 v[48:63], v[84:87], v[80:83], v[48:63]
    ds_read_b64_tr_b16 v[134:135], v169 offset:33792
    ds_read_b128 v[128:131], v161 offset:36864
    v_mfma_f32_4x4x4_16b_bf16 v[196:199], v[98:99], v[200:201], v[196:199]
    v_mfma_f32_32x32x16_bf16 v[32:47], v[96:99], v[88:91], v[32:47]
    ds_read_b128 v[136:139], v162 offset:32768
    ds_read_b64_tr_b16 v[144:145], v170 offset:32768
    v_mfma_f32_32x32x16_bf16 v[48:63], v[96:99], v[92:95], v[48:63]
    ds_read_b64_tr_b16 v[146:147], v170 offset:33792
    ds_read_b128 v[140:143], v162 offset:36864
    v_mfma_f32_32x32x16_bf16 v[32:47], v[108:111], v[100:103], v[32:47]
    ds_read_b128 v[148:151], v163 offset:32768
    ds_read_b64_tr_b16 v[156:157], v171 offset:32768
    v_mfma_f32_32x32x16_bf16 v[48:63], v[108:111], v[104:107], v[48:63]
    ds_read_b64_tr_b16 v[158:159], v171 offset:33792
    ds_read_b128 v[152:155], v163 offset:36864
    s_waitcnt lgkmcnt(0)
    v_mfma_f32_32x32x16_bf16 v[32:47], v[120:123], v[112:115], v[32:47]
    v_mfma_f32_4x4x4_16b_bf16 v[196:199], v[120:121], v[200:201], v[196:199]
    v_mfma_f32_32x32x16_bf16 v[48:63], v[120:123], v[116:119], v[48:63]
    s_nop 0
    v_mfma_f32_4x4x4_16b_bf16 v[196:199], v[144:145], v[200:201], v[196:199]
    v_mfma_f32_32x32x16_bf16 v[32:47], v[132:135], v[124:127], v[32:47]
    s_nop 0
    v_mfma_f32_4x4x4_16b_bf16 v[196:199], v[122:123], v[200:201], v[196:199]
    v_mfma_f32_32x32x16_bf16 v[48:63], v[132:135], v[128:131], v[48:63]
    s_nop 0
    v_mfma_f32_4x4x4_16b_bf16 v[196:199], v[146:147], v[200:201], v[196:199]
    v_mfma_f32_32x32x16_bf16 v[32:47], v[144:147], v[136:139], v[32:47]
    v_mfma_f32_32x32x16_bf16 v[48:63], v[144:147], v[140:143], v[48:63]
    v_mfma_f32_32x32x16_bf16 v[32:47], v[156:159], v[148:151], v[32:47]
    v_mfma_f32_32x32x16_bf16 v[48:63], v[156:159], v[152:155], v[48:63]
    v_and_b32 v4, 3, v1
    v_cmp_eq_u32 s[52:53], 1, v4
    v_cmp_eq_u32 s[54:55], 2, v4
    v_cmp_eq_u32 s[56:57], 3, v4
    v_cndmask_b32 v210, v196, v197, s[52:53]
    v_cndmask_b32 v210, v210, v198, s[54:55]
    v_cndmask_b32 v210, v210, v199, s[56:57]
    v_mov_b32 v64, v210
    s_nop 1
    v_permlane32_swap_b32 v210, v64
    v_add_f32 v210, v210, v64
    s_lshl_b32 s33, s30, 7
    s_add_u32 s33, s33, 132096
    s_lshl_b32 s34, s29, 9
    s_add_u32 s34, s34, s33
    v_lshlrev_b32 v68, 2, v2
    v_add_u32 v68, s34, v68
    ds_write_b32 v68, v210
    v_lshlrev_b32 v68, 4, v3
    v_add_u32 v68, s33, v68
    s_lshl_b32 s33, s29, 6
    s_movk_i32 s34, 1280
    s_cmp_lt_u32 s25, 5
    s_cselect_b32 s34, s34, 1536
    v_add_u32 v69, s33, v2
    v_mul_lo_u32 v69, v69, s34
    s_lshl_b32 s33, s30, 6
    v_lshlrev_b32 v71, 4, v3
    v_add_u32 v71, s33, v71
    v_add_u32 v69, v69, v71
    s_lshl_b32 s33, s34, 5
    v_add_u32 v71, s33, v69
    s_lshl_b32 s33, s34, 7
    s_mul_i32 s39, s33, s24
    s_add_u32 s39, s39, s27
    s_mov_b32 s33, 8388608
    s_cmp_lt_u32 s25, 5
    s_cselect_b32 s33, s33, 11010048
    s_add_u32 s39, s39, s33
    s_waitcnt lgkmcnt(0)
    s_barrier
    s_cmp_lt_u32 s25, 5
    s_cbranch_scc1 k2_phi
    ds_read_b128 v[72:75], v68 offset:0
    ds_read_b128 v[88:91], v68 offset:512
    ds_read_b128 v[76:79], v68 offset:32
    ds_read_b128 v[92:95], v68 offset:544
    ds_read_b128 v[80:83], v68 offset:64
    ds_read_b128 v[96:99], v68 offset:576
    ds_read_b128 v[84:87], v68 offset:96
    ds_read_b128 v[100:103], v68 offset:608
    v_mov_b32 v104, v202
    v_mov_b32 v105, v202
    v_mov_b32 v106, v203
    v_mov_b32 v107, v203
    v_mov_b32 v108, v204
    v_mov_b32 v109, v204
    v_mov_b32 v110, v205
    v_mov_b32 v111, v205
    s_waitcnt lgkmcnt(0)
    v_pk_add_f32 v[72:73], v[72:73], v[88:89]
    v_pk_add_f32 v[74:75], v[74:75], v[90:91]
    v_pk_add_f32 v[76:77], v[76:77], v[92:93]
    v_pk_add_f32 v[78:79], v[78:79], v[94:95]
    v_pk_add_f32 v[80:81], v[80:81], v[96:97]
    v_pk_add_f32 v[82:83], v[82:83], v[98:99]
    v_pk_add_f32 v[84:85], v[84:85], v[100:101]
    v_pk_add_f32 v[86:87], v[86:87], v[102:103]
    v_pk_fma_f32 v[32:33], v[104:105], v[72:73], v[32:33] neg_lo:[1,0,0] neg_hi:[1,0,0]
    v_pk_fma_f32 v[34:35], v[104:105], v[74:75], v[34:35] neg_lo:[1,0,0] neg_hi:[1,0,0]
    v_pk_fma_f32 v[36:37], v[104:105], v[76:77], v[36:37] neg_lo:[1,0,0] neg_hi:[1,0,0]
    v_pk_fma_f32 v[38:39], v[104:105], v[78:79], v[38:39] neg_lo:[1,0,0] neg_hi:[1,0,0]
    v_pk_fma_f32 v[40:41], v[104:105], v[80:81], v[40:41] neg_lo:[1,0,0] neg_hi:[1,0,0]
    v_pk_fma_f32 v[42:43], v[104:105], v[82:83], v[42:43] neg_lo:[1,0,0] neg_hi:[1,0,0]
    v_pk_fma_f32 v[44:45], v[104:105], v[84:85], v[44:45] neg_lo:[1,0,0] neg_hi:[1,0,0]
    v_pk_fma_f32 v[46:47], v[104:105], v[86:87], v[46:47] neg_lo:[1,0,0] neg_hi:[1,0,0]
    v_pk_mul_f32 v[32:33], v[32:33], v[106:107]
    v_pk_mul_f32 v[34:35], v[34:35], v[106:107]
    v_pk_mul_f32 v[36:37], v[36:37], v[106:107]
    v_pk_mul_f32 v[38:39], v[38:39], v[106:107]
    v_pk_mul_f32 v[40:41], v[40:41], v[106:107]
    v_pk_mul_f32 v[42:43], v[42:43], v[106:107]
    v_pk_mul_f32 v[44:45], v[44:45], v[106:107]
    v_pk_mul_f32 v[46:47], v[46:47], v[106:107]
    v_cvt_pk_bf16_f32 v112, v32, v33
    v_cvt_pk_bf16_f32 v113, v34, v35
    v_cvt_pk_bf16_f32 v114, v36, v37
    v_cvt_pk_bf16_f32 v115, v38, v39
    v_cvt_pk_bf16_f32 v116, v40, v41
    v_cvt_pk_bf16_f32 v117, v42, v43
    v_cvt_pk_bf16_f32 v118, v44, v45
    v_cvt_pk_bf16_f32 v119, v46, v47
    v_lshlrev_b32 v32, 16, v112
    v_and_b32 v33, 0xffff0000, v112
    v_lshlrev_b32 v34, 16, v113
    v_and_b32 v35, 0xffff0000, v113
    v_lshlrev_b32 v36, 16, v114
    v_and_b32 v37, 0xffff0000, v114
    v_lshlrev_b32 v38, 16, v115
    v_and_b32 v39, 0xffff0000, v115
    v_lshlrev_b32 v40, 16, v116
    v_and_b32 v41, 0xffff0000, v116
    v_lshlrev_b32 v42, 16, v117
    v_and_b32 v43, 0xffff0000, v117
    v_lshlrev_b32 v44, 16, v118
    v_and_b32 v45, 0xffff0000, v118
    v_lshlrev_b32 v46, 16, v119
    v_and_b32 v47, 0xffff0000, v119
    v_pk_mul_f32 v[128:129], v[32:33], v[32:33]
    v_pk_mul_f32 v[130:131], v[34:35], v[34:35]
    v_pk_mul_f32 v[132:133], v[36:37], v[36:37]
    v_pk_mul_f32 v[134:135], v[38:39], v[38:39]
    v_pk_mul_f32 v[136:137], v[40:41], v[40:41]
    v_pk_mul_f32 v[138:139], v[42:43], v[42:43]
    v_pk_mul_f32 v[140:141], v[44:45], v[44:45]
    v_pk_mul_f32 v[142:143], v[46:47], v[46:47]
    v_pk_mul_f32 v[144:145], v[32:33], v[248:249]
    v_pk_mul_f32 v[146:147], v[34:35], v[248:249]
    v_pk_mul_f32 v[148:149], v[36:37], v[248:249]
    v_pk_mul_f32 v[150:151], v[38:39], v[248:249]
    v_pk_mul_f32 v[152:153], v[40:41], v[248:249]
    v_pk_mul_f32 v[154:155], v[42:43], v[248:249]
    v_pk_mul_f32 v[156:157], v[44:45], v[248:249]
    v_pk_mul_f32 v[158:159], v[46:47], v[248:249]
    v_pk_fma_f32 v[128:129], v[128:129], v[246:247], v[240:241]
    v_pk_fma_f32 v[130:131], v[130:131], v[246:247], v[240:241]
    v_pk_fma_f32 v[132:133], v[132:133], v[246:247], v[240:241]
    v_pk_fma_f32 v[134:135], v[134:135], v[246:247], v[240:241]
    v_pk_fma_f32 v[136:137], v[136:137], v[246:247], v[240:241]
    v_pk_fma_f32 v[138:139], v[138:139], v[246:247], v[240:241]
    v_pk_fma_f32 v[140:141], v[140:141], v[246:247], v[240:241]
    v_pk_fma_f32 v[142:143], v[142:143], v[246:247], v[240:241]
    v_pk_mul_f32 v[128:129], v[128:129], v[144:145]
    v_pk_mul_f32 v[130:131], v[130:131], v[146:147]
    v_pk_mul_f32 v[132:133], v[132:133], v[148:149]
    v_pk_mul_f32 v[134:135], v[134:135], v[150:151]
    v_pk_mul_f32 v[136:137], v[136:137], v[152:153]
    v_pk_mul_f32 v[138:139], v[138:139], v[154:155]
    v_pk_mul_f32 v[140:141], v[140:141], v[156:157]
    v_pk_mul_f32 v[142:143], v[142:143], v[158:159]
    v_exp_f32 v128, v128
    v_exp_f32 v129, v129
    v_exp_f32 v130, v130
    v_exp_f32 v131, v131
    v_exp_f32 v132, v132
    v_exp_f32 v133, v133
    v_exp_f32 v134, v134
    v_exp_f32 v135, v135
    v_exp_f32 v136, v136
    v_exp_f32 v137, v137
    v_exp_f32 v138, v138
    v_exp_f32 v139, v139
    v_exp_f32 v140, v140
    v_exp_f32 v141, v141
    v_exp_f32 v142, v142
    v_exp_f32 v143, v143
    v_pk_add_f32 v[128:129], v[128:129], v[240:241]
    v_pk_add_f32 v[130:131], v[130:131], v[240:241]
    v_pk_add_f32 v[132:133], v[132:133], v[240:241]
    v_pk_add_f32 v[134:135], v[134:135], v[240:241]
    v_pk_add_f32 v[136:137], v[136:137], v[240:241]
    v_pk_add_f32 v[138:139], v[138:139], v[240:241]
    v_pk_add_f32 v[140:141], v[140:141], v[240:241]
    v_pk_add_f32 v[142:143], v[142:143], v[240:241]
    v_rcp_f32 v128, v128
    v_rcp_f32 v129, v129
    v_rcp_f32 v130, v130
    v_rcp_f32 v131, v131
    v_rcp_f32 v132, v132
    v_rcp_f32 v133, v133
    v_rcp_f32 v134, v134
    v_rcp_f32 v135, v135
    v_rcp_f32 v136, v136
    v_rcp_f32 v137, v137
    v_rcp_f32 v138, v138
    v_rcp_f32 v139, v139
    v_rcp_f32 v140, v140
    v_rcp_f32 v141, v141
    v_rcp_f32 v142, v142
    v_rcp_f32 v143, v143
    v_pk_mul_f32 v[128:129], v[128:129], v[32:33]
    v_pk_mul_f32 v[130:131], v[130:131], v[34:35]
    v_pk_mul_f32 v[132:133], v[132:133], v[36:37]
    v_pk_mul_f32 v[134:135], v[134:135], v[38:39]
    v_pk_mul_f32 v[136:137], v[136:137], v[40:41]
    v_pk_mul_f32 v[138:139], v[138:139], v[42:43]
    v_pk_mul_f32 v[140:141], v[140:141], v[44:45]
    v_pk_mul_f32 v[142:143], v[142:143], v[46:47]
    v_cvt_pk_bf16_f32 v120, v128, v129
    v_cvt_pk_bf16_f32 v121, v130, v131
    v_cvt_pk_bf16_f32 v122, v132, v133
    v_cvt_pk_bf16_f32 v123, v134, v135
    v_cvt_pk_bf16_f32 v124, v136, v137
    v_cvt_pk_bf16_f32 v125, v138, v139
    v_cvt_pk_bf16_f32 v126, v140, v141
    v_cvt_pk_bf16_f32 v127, v142, v143
    v_permlane32_swap_b32 v120, v122
    v_permlane32_swap_b32 v121, v123
    v_permlane32_swap_b32 v124, v126
    v_permlane32_swap_b32 v125, v127
    buffer_store_dwordx4 v[120:123], v69, s[20:23], s39 offen offset:0
    buffer_store_dwordx4 v[124:127], v69, s[20:23], s39 offen offset:32
    v_pk_fma_f32 v[48:49], v[108:109], v[72:73], v[48:49] neg_lo:[1,0,0] neg_hi:[1,0,0]
    v_pk_fma_f32 v[50:51], v[108:109], v[74:75], v[50:51] neg_lo:[1,0,0] neg_hi:[1,0,0]
    v_pk_fma_f32 v[52:53], v[108:109], v[76:77], v[52:53] neg_lo:[1,0,0] neg_hi:[1,0,0]
    v_pk_fma_f32 v[54:55], v[108:109], v[78:79], v[54:55] neg_lo:[1,0,0] neg_hi:[1,0,0]
    v_pk_fma_f32 v[56:57], v[108:109], v[80:81], v[56:57] neg_lo:[1,0,0] neg_hi:[1,0,0]
    v_pk_fma_f32 v[58:59], v[108:109], v[82:83], v[58:59] neg_lo:[1,0,0] neg_hi:[1,0,0]
    v_pk_fma_f32 v[60:61], v[108:109], v[84:85], v[60:61] neg_lo:[1,0,0] neg_hi:[1,0,0]
    v_pk_fma_f32 v[62:63], v[108:109], v[86:87], v[62:63] neg_lo:[1,0,0] neg_hi:[1,0,0]
    v_pk_mul_f32 v[48:49], v[48:49], v[110:111]
    v_pk_mul_f32 v[50:51], v[50:51], v[110:111]
    v_pk_mul_f32 v[52:53], v[52:53], v[110:111]
    v_pk_mul_f32 v[54:55], v[54:55], v[110:111]
    v_pk_mul_f32 v[56:57], v[56:57], v[110:111]
    v_pk_mul_f32 v[58:59], v[58:59], v[110:111]
    v_pk_mul_f32 v[60:61], v[60:61], v[110:111]
    v_pk_mul_f32 v[62:63], v[62:63], v[110:111]
    v_cvt_pk_bf16_f32 v160, v48, v49
    v_cvt_pk_bf16_f32 v161, v50, v51
    v_cvt_pk_bf16_f32 v162, v52, v53
    v_cvt_pk_bf16_f32 v163, v54, v55
    v_cvt_pk_bf16_f32 v164, v56, v57
    v_cvt_pk_bf16_f32 v165, v58, v59
    v_cvt_pk_bf16_f32 v166, v60, v61
    v_cvt_pk_bf16_f32 v167, v62, v63
    v_lshlrev_b32 v48, 16, v160
    v_and_b32 v49, 0xffff0000, v160
    v_lshlrev_b32 v50, 16, v161
    v_and_b32 v51, 0xffff0000, v161
    v_lshlrev_b32 v52, 16, v162
    v_and_b32 v53, 0xffff0000, v162
    v_lshlrev_b32 v54, 16, v163
    v_and_b32 v55, 0xffff0000, v163
    v_lshlrev_b32 v56, 16, v164
    v_and_b32 v57, 0xffff0000, v164
    v_lshlrev_b32 v58, 16, v165
    v_and_b32 v59, 0xffff0000, v165
    v_lshlrev_b32 v60, 16, v166
    v_and_b32 v61, 0xffff0000, v166
    v_lshlrev_b32 v62, 16, v167
    v_and_b32 v63, 0xffff0000, v167
    v_pk_mul_f32 v[176:177], v[48:49], v[48:49]
    v_pk_mul_f32 v[178:179], v[50:51], v[50:51]
    v_pk_mul_f32 v[180:181], v[52:53], v[52:53]
    v_pk_mul_f32 v[182:183], v[54:55], v[54:55]
    v_pk_mul_f32 v[184:185], v[56:57], v[56:57]
    v_pk_mul_f32 v[186:187], v[58:59], v[58:59]
    v_pk_mul_f32 v[188:189], v[60:61], v[60:61]
    v_pk_mul_f32 v[190:191], v[62:63], v[62:63]
    v_pk_mul_f32 v[192:193], v[48:49], v[248:249]
    v_pk_mul_f32 v[194:195], v[50:51], v[248:249]
    v_pk_mul_f32 v[196:197], v[52:53], v[248:249]
    v_pk_mul_f32 v[198:199], v[54:55], v[248:249]
    v_pk_mul_f32 v[200:201], v[56:57], v[248:249]
    v_pk_mul_f32 v[202:203], v[58:59], v[248:249]
    v_pk_mul_f32 v[204:205], v[60:61], v[248:249]
    v_pk_mul_f32 v[206:207], v[62:63], v[248:249]
    v_pk_fma_f32 v[176:177], v[176:177], v[246:247], v[240:241]
    v_pk_fma_f32 v[178:179], v[178:179], v[246:247], v[240:241]
    v_pk_fma_f32 v[180:181], v[180:181], v[246:247], v[240:241]
    v_pk_fma_f32 v[182:183], v[182:183], v[246:247], v[240:241]
    v_pk_fma_f32 v[184:185], v[184:185], v[246:247], v[240:241]
    v_pk_fma_f32 v[186:187], v[186:187], v[246:247], v[240:241]
    v_pk_fma_f32 v[188:189], v[188:189], v[246:247], v[240:241]
    v_pk_fma_f32 v[190:191], v[190:191], v[246:247], v[240:241]
    v_pk_mul_f32 v[176:177], v[176:177], v[192:193]
    v_pk_mul_f32 v[178:179], v[178:179], v[194:195]
    v_pk_mul_f32 v[180:181], v[180:181], v[196:197]
    v_pk_mul_f32 v[182:183], v[182:183], v[198:199]
    v_pk_mul_f32 v[184:185], v[184:185], v[200:201]
    v_pk_mul_f32 v[186:187], v[186:187], v[202:203]
    v_pk_mul_f32 v[188:189], v[188:189], v[204:205]
    v_pk_mul_f32 v[190:191], v[190:191], v[206:207]
    v_exp_f32 v176, v176
    v_exp_f32 v177, v177
    v_exp_f32 v178, v178
    v_exp_f32 v179, v179
    v_exp_f32 v180, v180
    v_exp_f32 v181, v181
    v_exp_f32 v182, v182
    v_exp_f32 v183, v183
    v_exp_f32 v184, v184
    v_exp_f32 v185, v185
    v_exp_f32 v186, v186
    v_exp_f32 v187, v187
    v_exp_f32 v188, v188
    v_exp_f32 v189, v189
    v_exp_f32 v190, v190
    v_exp_f32 v191, v191
    v_pk_add_f32 v[176:177], v[176:177], v[240:241]
    v_pk_add_f32 v[178:179], v[178:179], v[240:241]
    v_pk_add_f32 v[180:181], v[180:181], v[240:241]
    v_pk_add_f32 v[182:183], v[182:183], v[240:241]
    v_pk_add_f32 v[184:185], v[184:185], v[240:241]
    v_pk_add_f32 v[186:187], v[186:187], v[240:241]
    v_pk_add_f32 v[188:189], v[188:189], v[240:241]
    v_pk_add_f32 v[190:191], v[190:191], v[240:241]
    v_rcp_f32 v176, v176
    v_rcp_f32 v177, v177
    v_rcp_f32 v178, v178
    v_rcp_f32 v179, v179
    v_rcp_f32 v180, v180
    v_rcp_f32 v181, v181
    v_rcp_f32 v182, v182
    v_rcp_f32 v183, v183
    v_rcp_f32 v184, v184
    v_rcp_f32 v185, v185
    v_rcp_f32 v186, v186
    v_rcp_f32 v187, v187
    v_rcp_f32 v188, v188
    v_rcp_f32 v189, v189
    v_rcp_f32 v190, v190
    v_rcp_f32 v191, v191
    v_pk_mul_f32 v[176:177], v[176:177], v[48:49]
    v_pk_mul_f32 v[178:179], v[178:179], v[50:51]
    v_pk_mul_f32 v[180:181], v[180:181], v[52:53]
    v_pk_mul_f32 v[182:183], v[182:183], v[54:55]
    v_pk_mul_f32 v[184:185], v[184:185], v[56:57]
    v_pk_mul_f32 v[186:187], v[186:187], v[58:59]
    v_pk_mul_f32 v[188:189], v[188:189], v[60:61]
    v_pk_mul_f32 v[190:191], v[190:191], v[62:63]
    v_cvt_pk_bf16_f32 v168, v176, v177
    v_cvt_pk_bf16_f32 v169, v178, v179
    v_cvt_pk_bf16_f32 v170, v180, v181
    v_cvt_pk_bf16_f32 v171, v182, v183
    v_cvt_pk_bf16_f32 v172, v184, v185
    v_cvt_pk_bf16_f32 v173, v186, v187
    v_cvt_pk_bf16_f32 v174, v188, v189
    v_cvt_pk_bf16_f32 v175, v190, v191
    v_permlane32_swap_b32 v168, v170
    v_permlane32_swap_b32 v169, v171
    v_permlane32_swap_b32 v172, v174
    v_permlane32_swap_b32 v173, v175
    buffer_store_dwordx4 v[168:171], v71, s[20:23], s39 offen offset:0
    buffer_store_dwordx4 v[172:175], v71, s[20:23], s39 offen offset:32
    s_endpgm
k2_phi:
    s_nop 4
    ds_read_b128 v[72:75], v68 offset:0
    ds_read_b128 v[88:91], v68 offset:512
    ds_read_b128 v[76:79], v68 offset:32
    ds_read_b128 v[92:95], v68 offset:544
    ds_read_b128 v[80:83], v68 offset:64
    ds_read_b128 v[96:99], v68 offset:576
    ds_read_b128 v[84:87], v68 offset:96
    ds_read_b128 v[100:103], v68 offset:608
    v_mov_b32 v104, v202
    v_mov_b32 v105, v202
    v_mov_b32 v106, v203
    v_mov_b32 v107, v203
    v_mov_b32 v108, v204
    v_mov_b32 v109, v204
    v_mov_b32 v110, v205
    v_mov_b32 v111, v205
    s_waitcnt lgkmcnt(0)
    v_pk_add_f32 v[72:73], v[72:73], v[88:89]
    v_pk_add_f32 v[74:75], v[74:75], v[90:91]
    v_pk_add_f32 v[76:77], v[76:77], v[92:93]
    v_pk_add_f32 v[78:79], v[78:79], v[94:95]
    v_pk_add_f32 v[80:81], v[80:81], v[96:97]
    v_pk_add_f32 v[82:83], v[82:83], v[98:99]
    v_pk_add_f32 v[84:85], v[84:85], v[100:101]
    v_pk_add_f32 v[86:87], v[86:87], v[102:103]
    v_pk_fma_f32 v[32:33], v[104:105], v[72:73], v[32:33] neg_lo:[1,0,0] neg_hi:[1,0,0]
    v_pk_fma_f32 v[34:35], v[104:105], v[74:75], v[34:35] neg_lo:[1,0,0] neg_hi:[1,0,0]
    v_pk_fma_f32 v[36:37], v[104:105], v[76:77], v[36:37] neg_lo:[1,0,0] neg_hi:[1,0,0]
    v_pk_fma_f32 v[38:39], v[104:105], v[78:79], v[38:39] neg_lo:[1,0,0] neg_hi:[1,0,0]
    v_pk_fma_f32 v[40:41], v[104:105], v[80:81], v[40:41] neg_lo:[1,0,0] neg_hi:[1,0,0]
    v_pk_fma_f32 v[42:43], v[104:105], v[82:83], v[42:43] neg_lo:[1,0,0] neg_hi:[1,0,0]
    v_pk_fma_f32 v[44:45], v[104:105], v[84:85], v[44:45] neg_lo:[1,0,0] neg_hi:[1,0,0]
    v_pk_fma_f32 v[46:47], v[104:105], v[86:87], v[46:47] neg_lo:[1,0,0] neg_hi:[1,0,0]
    v_pk_mul_f32 v[32:33], v[32:33], v[106:107]
    v_pk_mul_f32 v[34:35], v[34:35], v[106:107]
    v_pk_mul_f32 v[36:37], v[36:37], v[106:107]
    v_pk_mul_f32 v[38:39], v[38:39], v[106:107]
    v_pk_mul_f32 v[40:41], v[40:41], v[106:107]
    v_pk_mul_f32 v[42:43], v[42:43], v[106:107]
    v_pk_mul_f32 v[44:45], v[44:45], v[106:107]
    v_pk_mul_f32 v[46:47], v[46:47], v[106:107]
    v_cvt_pk_bf16_f32 v112, v32, v33
    v_cvt_pk_bf16_f32 v113, v34, v35
    v_cvt_pk_bf16_f32 v114, v36, v37
    v_cvt_pk_bf16_f32 v115, v38, v39
    v_cvt_pk_bf16_f32 v116, v40, v41
    v_cvt_pk_bf16_f32 v117, v42, v43
    v_cvt_pk_bf16_f32 v118, v44, v45
    v_cvt_pk_bf16_f32 v119, v46, v47
    v_lshlrev_b32 v32, 16, v112
    v_and_b32 v33, 0xffff0000, v112
    v_lshlrev_b32 v34, 16, v113
    v_and_b32 v35, 0xffff0000, v113
    v_lshlrev_b32 v36, 16, v114
    v_and_b32 v37, 0xffff0000, v114
    v_lshlrev_b32 v38, 16, v115
    v_and_b32 v39, 0xffff0000, v115
    v_lshlrev_b32 v40, 16, v116
    v_and_b32 v41, 0xffff0000, v116
    v_lshlrev_b32 v42, 16, v117
    v_and_b32 v43, 0xffff0000, v117
    v_lshlrev_b32 v44, 16, v118
    v_and_b32 v45, 0xffff0000, v118
    v_lshlrev_b32 v46, 16, v119
    v_and_b32 v47, 0xffff0000, v119
    v_pk_mul_f32 v[128:129], v[32:33], v[242:243]
    v_pk_mul_f32 v[130:131], v[34:35], v[242:243]
    v_pk_mul_f32 v[132:133], v[36:37], v[242:243]
    v_pk_mul_f32 v[134:135], v[38:39], v[242:243]
    v_pk_mul_f32 v[136:137], v[40:41], v[242:243]
    v_pk_mul_f32 v[138:139], v[42:43], v[242:243]
    v_pk_mul_f32 v[140:141], v[44:45], v[242:243]
    v_pk_mul_f32 v[142:143], v[46:47], v[242:243]
    v_exp_f32 v128, v128
    v_exp_f32 v129, v129
    v_exp_f32 v130, v130
    v_exp_f32 v131, v131
    v_exp_f32 v132, v132
    v_exp_f32 v133, v133
    v_exp_f32 v134, v134
    v_exp_f32 v135, v135
    v_exp_f32 v136, v136
    v_exp_f32 v137, v137
    v_exp_f32 v138, v138
    v_exp_f32 v139, v139
    v_exp_f32 v140, v140
    v_exp_f32 v141, v141
    v_exp_f32 v142, v142
    v_exp_f32 v143, v143
    v_pk_add_f32 v[144:145], v[32:33], v[240:241]
    v_pk_add_f32 v[146:147], v[34:35], v[240:241]
    v_pk_add_f32 v[148:149], v[36:37], v[240:241]
    v_pk_add_f32 v[150:151], v[38:39], v[240:241]
    v_pk_add_f32 v[152:153], v[40:41], v[240:241]
    v_pk_add_f32 v[154:155], v[42:43], v[240:241]
    v_pk_add_f32 v[156:157], v[44:45], v[240:241]
    v_pk_add_f32 v[158:159], v[46:47], v[240:241]
    v_cvt_pk_bf16_f32 v112, v128, v129
    v_cvt_pk_bf16_f32 v113, v130, v131
    v_cvt_pk_bf16_f32 v114, v132, v133
    v_cvt_pk_bf16_f32 v115, v134, v135
    v_cvt_pk_bf16_f32 v116, v136, v137
    v_cvt_pk_bf16_f32 v117, v138, v139
    v_cvt_pk_bf16_f32 v118, v140, v141
    v_cvt_pk_bf16_f32 v119, v142, v143
    v_lshlrev_b32 v128, 16, v112
    v_and_b32 v129, 0xffff0000, v112
    v_lshlrev_b32 v130, 16, v113
    v_and_b32 v131, 0xffff0000, v113
    v_lshlrev_b32 v132, 16, v114
    v_and_b32 v133, 0xffff0000, v114
    v_lshlrev_b32 v134, 16, v115
    v_and_b32 v135, 0xffff0000, v115
    v_lshlrev_b32 v136, 16, v116
    v_and_b32 v137, 0xffff0000, v116
    v_lshlrev_b32 v138, 16, v117
    v_and_b32 v139, 0xffff0000, v117
    v_lshlrev_b32 v140, 16, v118
    v_and_b32 v141, 0xffff0000, v118
    v_lshlrev_b32 v142, 16, v119
    v_and_b32 v143, 0xffff0000, v119
    v_pk_add_f32 v[128:129], v[128:129], v[244:245]
    v_pk_add_f32 v[130:131], v[130:131], v[244:245]
    v_pk_add_f32 v[132:133], v[132:133], v[244:245]
    v_pk_add_f32 v[134:135], v[134:135], v[244:245]
    v_pk_add_f32 v[136:137], v[136:137], v[244:245]
    v_pk_add_f32 v[138:139], v[138:139], v[244:245]
    v_pk_add_f32 v[140:141], v[140:141], v[244:245]
    v_pk_add_f32 v[142:143], v[142:143], v[244:245]
    v_cmp_lt_f32 s[52:53], 0, v32
    v_cmp_lt_f32 s[54:55], 0, v33
    v_cmp_lt_f32 s[56:57], 0, v34
    v_cmp_lt_f32 s[58:59], 0, v35
    v_cndmask_b32 v128, v128, v144, s[52:53]
    v_cndmask_b32 v129, v129, v145, s[54:55]
    v_cndmask_b32 v130, v130, v146, s[56:57]
    v_cndmask_b32 v131, v131, v147, s[58:59]
    v_cmp_lt_f32 s[52:53], 0, v36
    v_cmp_lt_f32 s[54:55], 0, v37
    v_cmp_lt_f32 s[56:57], 0, v38
    v_cmp_lt_f32 s[58:59], 0, v39
    v_cndmask_b32 v132, v132, v148, s[52:53]
    v_cndmask_b32 v133, v133, v149, s[54:55]
    v_cndmask_b32 v134, v134, v150, s[56:57]
    v_cndmask_b32 v135, v135, v151, s[58:59]
    v_cmp_lt_f32 s[52:53], 0, v40
    v_cmp_lt_f32 s[54:55], 0, v41
    v_cmp_lt_f32 s[56:57], 0, v42
    v_cmp_lt_f32 s[58:59], 0, v43
    v_cndmask_b32 v136, v136, v152, s[52:53]
    v_cndmask_b32 v137, v137, v153, s[54:55]
    v_cndmask_b32 v138, v138, v154, s[56:57]
    v_cndmask_b32 v139, v139, v155, s[58:59]
    v_cmp_lt_f32 s[52:53], 0, v44
    v_cmp_lt_f32 s[54:55], 0, v45
    v_cmp_lt_f32 s[56:57], 0, v46
    v_cmp_lt_f32 s[58:59], 0, v47
    v_cndmask_b32 v140, v140, v156, s[52:53]
    v_cndmask_b32 v141, v141, v157, s[54:55]
    v_cndmask_b32 v142, v142, v158, s[56:57]
    v_cndmask_b32 v143, v143, v159, s[58:59]
    v_cvt_pk_bf16_f32 v120, v128, v129
    v_cvt_pk_bf16_f32 v121, v130, v131
    v_cvt_pk_bf16_f32 v122, v132, v133
    v_cvt_pk_bf16_f32 v123, v134, v135
    v_cvt_pk_bf16_f32 v124, v136, v137
    v_cvt_pk_bf16_f32 v125, v138, v139
    v_cvt_pk_bf16_f32 v126, v140, v141
    v_cvt_pk_bf16_f32 v127, v142, v143
    v_permlane32_swap_b32 v120, v122
    v_permlane32_swap_b32 v121, v123
    v_permlane32_swap_b32 v124, v126
    v_permlane32_swap_b32 v125, v127
    buffer_store_dwordx4 v[120:123], v69, s[20:23], s39 offen offset:0
    buffer_store_dwordx4 v[124:127], v69, s[20:23], s39 offen offset:32
    v_pk_fma_f32 v[48:49], v[108:109], v[72:73], v[48:49] neg_lo:[1,0,0] neg_hi:[1,0,0]
    v_pk_fma_f32 v[50:51], v[108:109], v[74:75], v[50:51] neg_lo:[1,0,0] neg_hi:[1,0,0]
    v_pk_fma_f32 v[52:53], v[108:109], v[76:77], v[52:53] neg_lo:[1,0,0] neg_hi:[1,0,0]
    v_pk_fma_f32 v[54:55], v[108:109], v[78:79], v[54:55] neg_lo:[1,0,0] neg_hi:[1,0,0]
    v_pk_fma_f32 v[56:57], v[108:109], v[80:81], v[56:57] neg_lo:[1,0,0] neg_hi:[1,0,0]
    v_pk_fma_f32 v[58:59], v[108:109], v[82:83], v[58:59] neg_lo:[1,0,0] neg_hi:[1,0,0]
    v_pk_fma_f32 v[60:61], v[108:109], v[84:85], v[60:61] neg_lo:[1,0,0] neg_hi:[1,0,0]
    v_pk_fma_f32 v[62:63], v[108:109], v[86:87], v[62:63] neg_lo:[1,0,0] neg_hi:[1,0,0]
    v_pk_mul_f32 v[48:49], v[48:49], v[110:111]
    v_pk_mul_f32 v[50:51], v[50:51], v[110:111]
    v_pk_mul_f32 v[52:53], v[52:53], v[110:111]
    v_pk_mul_f32 v[54:55], v[54:55], v[110:111]
    v_pk_mul_f32 v[56:57], v[56:57], v[110:111]
    v_pk_mul_f32 v[58:59], v[58:59], v[110:111]
    v_pk_mul_f32 v[60:61], v[60:61], v[110:111]
    v_pk_mul_f32 v[62:63], v[62:63], v[110:111]
    v_cvt_pk_bf16_f32 v160, v48, v49
    v_cvt_pk_bf16_f32 v161, v50, v51
    v_cvt_pk_bf16_f32 v162, v52, v53
    v_cvt_pk_bf16_f32 v163, v54, v55
    v_cvt_pk_bf16_f32 v164, v56, v57
    v_cvt_pk_bf16_f32 v165, v58, v59
    v_cvt_pk_bf16_f32 v166, v60, v61
    v_cvt_pk_bf16_f32 v167, v62, v63
    v_lshlrev_b32 v48, 16, v160
    v_and_b32 v49, 0xffff0000, v160
    v_lshlrev_b32 v50, 16, v161
    v_and_b32 v51, 0xffff0000, v161
    v_lshlrev_b32 v52, 16, v162
    v_and_b32 v53, 0xffff0000, v162
    v_lshlrev_b32 v54, 16, v163
    v_and_b32 v55, 0xffff0000, v163
    v_lshlrev_b32 v56, 16, v164
    v_and_b32 v57, 0xffff0000, v164
    v_lshlrev_b32 v58, 16, v165
    v_and_b32 v59, 0xffff0000, v165
    v_lshlrev_b32 v60, 16, v166
    v_and_b32 v61, 0xffff0000, v166
    v_lshlrev_b32 v62, 16, v167
    v_and_b32 v63, 0xffff0000, v167
    v_pk_mul_f32 v[176:177], v[48:49], v[242:243]
    v_pk_mul_f32 v[178:179], v[50:51], v[242:243]
    v_pk_mul_f32 v[180:181], v[52:53], v[242:243]
    v_pk_mul_f32 v[182:183], v[54:55], v[242:243]
    v_pk_mul_f32 v[184:185], v[56:57], v[242:243]
    v_pk_mul_f32 v[186:187], v[58:59], v[242:243]
    v_pk_mul_f32 v[188:189], v[60:61], v[242:243]
    v_pk_mul_f32 v[190:191], v[62:63], v[242:243]
    v_exp_f32 v176, v176
    v_exp_f32 v177, v177
    v_exp_f32 v178, v178
    v_exp_f32 v179, v179
    v_exp_f32 v180, v180
    v_exp_f32 v181, v181
    v_exp_f32 v182, v182
    v_exp_f32 v183, v183
    v_exp_f32 v184, v184
    v_exp_f32 v185, v185
    v_exp_f32 v186, v186
    v_exp_f32 v187, v187
    v_exp_f32 v188, v188
    v_exp_f32 v189, v189
    v_exp_f32 v190, v190
    v_exp_f32 v191, v191
    v_pk_add_f32 v[192:193], v[48:49], v[240:241]
    v_pk_add_f32 v[194:195], v[50:51], v[240:241]
    v_pk_add_f32 v[196:197], v[52:53], v[240:241]
    v_pk_add_f32 v[198:199], v[54:55], v[240:241]
    v_pk_add_f32 v[200:201], v[56:57], v[240:241]
    v_pk_add_f32 v[202:203], v[58:59], v[240:241]
    v_pk_add_f32 v[204:205], v[60:61], v[240:241]
    v_pk_add_f32 v[206:207], v[62:63], v[240:241]
    v_cvt_pk_bf16_f32 v160, v176, v177
    v_cvt_pk_bf16_f32 v161, v178, v179
    v_cvt_pk_bf16_f32 v162, v180, v181
    v_cvt_pk_bf16_f32 v163, v182, v183
    v_cvt_pk_bf16_f32 v164, v184, v185
    v_cvt_pk_bf16_f32 v165, v186, v187
    v_cvt_pk_bf16_f32 v166, v188, v189
    v_cvt_pk_bf16_f32 v167, v190, v191
    v_lshlrev_b32 v176, 16, v160
    v_and_b32 v177, 0xffff0000, v160
    v_lshlrev_b32 v178, 16, v161
    v_and_b32 v179, 0xffff0000, v161
    v_lshlrev_b32 v180, 16, v162
    v_and_b32 v181, 0xffff0000, v162
    v_lshlrev_b32 v182, 16, v163
    v_and_b32 v183, 0xffff0000, v163
    v_lshlrev_b32 v184, 16, v164
    v_and_b32 v185, 0xffff0000, v164
    v_lshlrev_b32 v186, 16, v165
    v_and_b32 v187, 0xffff0000, v165
    v_lshlrev_b32 v188, 16, v166
    v_and_b32 v189, 0xffff0000, v166
    v_lshlrev_b32 v190, 16, v167
    v_and_b32 v191, 0xffff0000, v167
    v_pk_add_f32 v[176:177], v[176:177], v[244:245]
    v_pk_add_f32 v[178:179], v[178:179], v[244:245]
    v_pk_add_f32 v[180:181], v[180:181], v[244:245]
    v_pk_add_f32 v[182:183], v[182:183], v[244:245]
    v_pk_add_f32 v[184:185], v[184:185], v[244:245]
    v_pk_add_f32 v[186:187], v[186:187], v[244:245]
    v_pk_add_f32 v[188:189], v[188:189], v[244:245]
    v_pk_add_f32 v[190:191], v[190:191], v[244:245]
    v_cmp_lt_f32 s[52:53], 0, v48
    v_cmp_lt_f32 s[54:55], 0, v49
    v_cmp_lt_f32 s[56:57], 0, v50
    v_cmp_lt_f32 s[58:59], 0, v51
    v_cndmask_b32 v176, v176, v192, s[52:53]
    v_cndmask_b32 v177, v177, v193, s[54:55]
    v_cndmask_b32 v178, v178, v194, s[56:57]
    v_cndmask_b32 v179, v179, v195, s[58:59]
    v_cmp_lt_f32 s[52:53], 0, v52
    v_cmp_lt_f32 s[54:55], 0, v53
    v_cmp_lt_f32 s[56:57], 0, v54
    v_cmp_lt_f32 s[58:59], 0, v55
    v_cndmask_b32 v180, v180, v196, s[52:53]
    v_cndmask_b32 v181, v181, v197, s[54:55]
    v_cndmask_b32 v182, v182, v198, s[56:57]
    v_cndmask_b32 v183, v183, v199, s[58:59]
    v_cmp_lt_f32 s[52:53], 0, v56
    v_cmp_lt_f32 s[54:55], 0, v57
    v_cmp_lt_f32 s[56:57], 0, v58
    v_cmp_lt_f32 s[58:59], 0, v59
    v_cndmask_b32 v184, v184, v200, s[52:53]
    v_cndmask_b32 v185, v185, v201, s[54:55]
    v_cndmask_b32 v186, v186, v202, s[56:57]
    v_cndmask_b32 v187, v187, v203, s[58:59]
    v_cmp_lt_f32 s[52:53], 0, v60
    v_cmp_lt_f32 s[54:55], 0, v61
    v_cmp_lt_f32 s[56:57], 0, v62
    v_cmp_lt_f32 s[58:59], 0, v63
    v_cndmask_b32 v188, v188, v204, s[52:53]
    v_cndmask_b32 v189, v189, v205, s[54:55]
    v_cndmask_b32 v190, v190, v206, s[56:57]
    v_cndmask_b32 v191, v191, v207, s[58:59]
    v_cvt_pk_bf16_f32 v168, v176, v177
    v_cvt_pk_bf16_f32 v169, v178, v179
    v_cvt_pk_bf16_f32 v170, v180, v181
    v_cvt_pk_bf16_f32 v171, v182, v183
    v_cvt_pk_bf16_f32 v172, v184, v185
    v_cvt_pk_bf16_f32 v173, v186, v187
    v_cvt_pk_bf16_f32 v174, v188, v189
    v_cvt_pk_bf16_f32 v175, v190, v191
    v_permlane32_swap_b32 v168, v170
    v_permlane32_swap_b32 v169, v171
    v_permlane32_swap_b32 v172, v174
    v_permlane32_swap_b32 v173, v175
    buffer_store_dwordx4 v[168:171], v71, s[20:23], s39 offen offset:0
    buffer_store_dwordx4 v[172:175], v71, s[20:23], s39 offen offset:32
    s_endpgm
k2_ln:
    s_waitcnt lgkmcnt(0)
    s_sub_u32 s24, s2, 176
    s_mov_b32 s20, s10
    s_and_b32 s21, s11, 0xffff
    s_mov_b32 s22, 25182208
    s_mov_b32 s23, 0x00020000
    v_and_b32 v1, 63, v0
    v_lshrrev_b32 v2, 3, v1
    v_and_b32 v3, 7, v1
    s_mul_i32 s33, s28, 96
    v_add_u32 v2, s33, v2
    v_lshlrev_b32 v2, 12, v2
    v_lshlrev_b32 v4, 4, v3
    v_add_u32 v2, v2, v4
    s_lshl_b32 s33, s24, 7
    v_add_u32 v2, s33, v2
    s_mov_b32 s34, 5242880
    buffer_load_dwordx4 v[16:19], v2, s[20:23], s34 offen
    s_mov_b32 s34, 5275648
    buffer_load_dwordx4 v[20:23], v2, s[20:23], s34 offen
    s_mov_b32 s34, 5308416
    buffer_load_dwordx4 v[24:27], v2, s[20:23], s34 offen
    s_mov_b32 s34, 5341184
    buffer_load_dwordx4 v[28:31], v2, s[20:23], s34 offen
    s_mov_b32 s34, 5373952
    buffer_load_dwordx4 v[32:35], v2, s[20:23], s34 offen
    s_mov_b32 s34, 5406720
    buffer_load_dwordx4 v[36:39], v2, s[20:23], s34 offen
    s_mov_b32 s34, 5439488
    buffer_load_dwordx4 v[40:43], v2, s[20:23], s34 offen
    s_mov_b32 s34, 5472256
    buffer_load_dwordx4 v[44:47], v2, s[20:23], s34 offen
    s_mov_b32 s34, 5505024
    buffer_load_dwordx4 v[48:51], v2, s[20:23], s34 offen
    s_mov_b32 s34, 5537792
    buffer_load_dwordx4 v[52:55], v2, s[20:23], s34 offen
    s_mov_b32 s34, 5570560
    buffer_load_dwordx4 v[56:59], v2, s[20:23], s34 offen
    s_mov_b32 s34, 5603328
    buffer_load_dwordx4 v[60:63], v2, s[20:23], s34 offen
    v_mov_b32 v160, 0
    v_mov_b32 v161, 0
    v_mov_b32 v162, 0
    v_mov_b32 v163, 0
    v_mov_b32 v164, 0
    v_mov_b32 v165, 0
    v_mov_b32 v166, 0
    v_mov_b32 v167, 0
    v_lshrrev_b32 v7, 2, v3
    v_lshlrev_b32 v7, 10, v7
    v_lshrrev_b32 v8, 3, v1
    v_lshlrev_b32 v8, 4, v8
    v_add_u32 v7, v7, v8
    v_and_b32 v8, 3, v3
    v_lshlrev_b32 v8, 8, v8
    v_add_u32 v7, v7, v8
    s_mul_i32 s35, s28, 393216
    s_lshl_b32 s33, s24, 11
    s_add_u32 s35, s35, s33
    s_add_u32 s35, s35, 14155776
    v_lshlrev_b32 v5, 5, v3
    s_lshl_b32 s33, s28, 8
    v_add_u32 v6, s33, v5
    s_waitcnt vmcnt(11)
    v_lshlrev_b32 v64, 16, v16
    v_and_b32 v65, 0xffff0000, v16
    v_lshlrev_b32 v66, 16, v17
    v_and_b32 v67, 0xffff0000, v17
    v_lshlrev_b32 v68, 16, v18
    v_and_b32 v69, 0xffff0000, v18
    v_lshlrev_b32 v70, 16, v19
    v_and_b32 v71, 0xffff0000, v19
    v_pk_add_f32 v[160:161], v[160:161], v[64:65]
    v_pk_add_f32 v[162:163], v[162:163], v[66:67]
    v_pk_add_f32 v[164:165], v[164:165], v[68:69]
    v_pk_add_f32 v[166:167], v[166:167], v[70:71]
    s_waitcnt vmcnt(10)
    v_lshlrev_b32 v72, 16, v20
    v_and_b32 v73, 0xffff0000, v20
    v_lshlrev_b32 v74, 16, v21
    v_and_b32 v75, 0xffff0000, v21
    v_lshlrev_b32 v76, 16, v22
    v_and_b32 v77, 0xffff0000, v22
    v_lshlrev_b32 v78, 16, v23
    v_and_b32 v79, 0xffff0000, v23
    v_pk_add_f32 v[160:161], v[160:161], v[72:73]
    v_pk_add_f32 v[162:163], v[162:163], v[74:75]
    v_pk_add_f32 v[164:165], v[164:165], v[76:77]
    v_pk_add_f32 v[166:167], v[166:167], v[78:79]
    s_waitcnt vmcnt(9)
    v_lshlrev_b32 v80, 16, v24
    v_and_b32 v81, 0xffff0000, v24
    v_lshlrev_b32 v82, 16, v25
    v_and_b32 v83, 0xffff0000, v25
    v_lshlrev_b32 v84, 16, v26
    v_and_b32 v85, 0xffff0000, v26
    v_lshlrev_b32 v86, 16, v27
    v_and_b32 v87, 0xffff0000, v27
    v_pk_add_f32 v[160:161], v[160:161], v[80:81]
    v_pk_add_f32 v[162:163], v[162:163], v[82:83]
    v_pk_add_f32 v[164:165], v[164:165], v[84:85]
    v_pk_add_f32 v[166:167], v[166:167], v[86:87]
    s_waitcnt vmcnt(8)
    v_lshlrev_b32 v88, 16, v28
    v_and_b32 v89, 0xffff0000, v28
    v_lshlrev_b32 v90, 16, v29
    v_and_b32 v91, 0xffff0000, v29
    v_lshlrev_b32 v92, 16, v30
    v_and_b32 v93, 0xffff0000, v30
    v_lshlrev_b32 v94, 16, v31
    v_and_b32 v95, 0xffff0000, v31
    v_pk_add_f32 v[160:161], v[160:161], v[88:89]
    v_pk_add_f32 v[162:163], v[162:163], v[90:91]
    v_pk_add_f32 v[164:165], v[164:165], v[92:93]
    v_pk_add_f32 v[166:167], v[166:167], v[94:95]
    s_waitcnt vmcnt(7)
    v_lshlrev_b32 v96, 16, v32
    v_and_b32 v97, 0xffff0000, v32
    v_lshlrev_b32 v98, 16, v33
    v_and_b32 v99, 0xffff0000, v33
    v_lshlrev_b32 v100, 16, v34
    v_and_b32 v101, 0xffff0000, v34
    v_lshlrev_b32 v102, 16, v35
    v_and_b32 v103, 0xffff0000, v35
    v_pk_add_f32 v[160:161], v[160:161], v[96:97]
    v_pk_add_f32 v[162:163], v[162:163], v[98:99]
    v_pk_add_f32 v[164:165], v[164:165], v[100:101]
    v_pk_add_f32 v[166:167], v[166:167], v[102:103]
    s_waitcnt vmcnt(6)
    v_lshlrev_b32 v104, 16, v36
    v_and_b32 v105, 0xffff0000, v36
    v_lshlrev_b32 v106, 16, v37
    v_and_b32 v107, 0xffff0000, v37
    v_lshlrev_b32 v108, 16, v38
    v_and_b32 v109, 0xffff0000, v38
    v_lshlrev_b32 v110, 16, v39
    v_and_b32 v111, 0xffff0000, v39
    v_pk_add_f32 v[160:161], v[160:161], v[104:105]
    v_pk_add_f32 v[162:163], v[162:163], v[106:107]
    v_pk_add_f32 v[164:165], v[164:165], v[108:109]
    v_pk_add_f32 v[166:167], v[166:167], v[110:111]
    s_waitcnt vmcnt(5)
    v_lshlrev_b32 v112, 16, v40
    v_and_b32 v113, 0xffff0000, v40
    v_lshlrev_b32 v114, 16, v41
    v_and_b32 v115, 0xffff0000, v41
    v_lshlrev_b32 v116, 16, v42
    v_and_b32 v117, 0xffff0000, v42
    v_lshlrev_b32 v118, 16, v43
    v_and_b32 v119, 0xffff0000, v43
    v_pk_add_f32 v[160:161], v[160:161], v[112:113]
    v_pk_add_f32 v[162:163], v[162:163], v[114:115]
    v_pk_add_f32 v[164:165], v[164:165], v[116:117]
    v_pk_add_f32 v[166:167], v[166:167], v[118:119]
    s_waitcnt vmcnt(4)
    v_lshlrev_b32 v120, 16, v44
    v_and_b32 v121, 0xffff0000, v44
    v_lshlrev_b32 v122, 16, v45
    v_and_b32 v123, 0xffff0000, v45
    v_lshlrev_b32 v124, 16, v46
    v_and_b32 v125, 0xffff0000, v46
    v_lshlrev_b32 v126, 16, v47
    v_and_b32 v127, 0xffff0000, v47
    v_pk_add_f32 v[160:161], v[160:161], v[120:121]
    v_pk_add_f32 v[162:163], v[162:163], v[122:123]
    v_pk_add_f32 v[164:165], v[164:165], v[124:125]
    v_pk_add_f32 v[166:167], v[166:167], v[126:127]
    s_waitcnt vmcnt(3)
    v_lshlrev_b32 v128, 16, v48
    v_and_b32 v129, 0xffff0000, v48
    v_lshlrev_b32 v130, 16, v49
    v_and_b32 v131, 0xffff0000, v49
    v_lshlrev_b32 v132, 16, v50
    v_and_b32 v133, 0xffff0000, v50
    v_lshlrev_b32 v134, 16, v51
    v_and_b32 v135, 0xffff0000, v51
    v_pk_add_f32 v[160:161], v[160:161], v[128:129]
    v_pk_add_f32 v[162:163], v[162:163], v[130:131]
    v_pk_add_f32 v[164:165], v[164:165], v[132:133]
    v_pk_add_f32 v[166:167], v[166:167], v[134:135]
    s_waitcnt vmcnt(2)
    v_lshlrev_b32 v136, 16, v52
    v_and_b32 v137, 0xffff0000, v52
    v_lshlrev_b32 v138, 16, v53
    v_and_b32 v139, 0xffff0000, v53
    v_lshlrev_b32 v140, 16, v54
    v_and_b32 v141, 0xffff0000, v54
    v_lshlrev_b32 v142, 16, v55
    v_and_b32 v143, 0xffff0000, v55
    v_pk_add_f32 v[160:161], v[160:161], v[136:137]
    v_pk_add_f32 v[162:163], v[162:163], v[138:139]
    v_pk_add_f32 v[164:165], v[164:165], v[140:141]
    v_pk_add_f32 v[166:167], v[166:167], v[142:143]
    s_waitcnt vmcnt(1)
    v_lshlrev_b32 v144, 16, v56
    v_and_b32 v145, 0xffff0000, v56
    v_lshlrev_b32 v146, 16, v57
    v_and_b32 v147, 0xffff0000, v57
    v_lshlrev_b32 v148, 16, v58
    v_and_b32 v149, 0xffff0000, v58
    v_lshlrev_b32 v150, 16, v59
    v_and_b32 v151, 0xffff0000, v59
    v_pk_add_f32 v[160:161], v[160:161], v[144:145]
    v_pk_add_f32 v[162:163], v[162:163], v[146:147]
    v_pk_add_f32 v[164:165], v[164:165], v[148:149]
    v_pk_add_f32 v[166:167], v[166:167], v[150:151]
    s_waitcnt vmcnt(0)
    v_lshlrev_b32 v152, 16, v60
    v_and_b32 v153, 0xffff0000, v60
    v_lshlrev_b32 v154, 16, v61
    v_and_b32 v155, 0xffff0000, v61
    v_lshlrev_b32 v156, 16, v62
    v_and_b32 v157, 0xffff0000, v62
    v_lshlrev_b32 v158, 16, v63
    v_and_b32 v159, 0xffff0000, v63
    v_pk_add_f32 v[160:161], v[160:161], v[152:153]
    v_pk_add_f32 v[162:163], v[162:163], v[154:155]
    v_pk_add_f32 v[164:165], v[164:165], v[156:157]
    v_pk_add_f32 v[166:167], v[166:167], v[158:159]
    v_add_f32_dpp v160, v160, v160 row_ror:8 row_mask:0xf bank_mask:0xf
    v_add_f32_dpp v161, v161, v161 row_ror:8 row_mask:0xf bank_mask:0xf
    v_add_f32_dpp v162, v162, v162 row_ror:8 row_mask:0xf bank_mask:0xf
    v_add_f32_dpp v163, v163, v163 row_ror:8 row_mask:0xf bank_mask:0xf
    v_add_f32_dpp v164, v164, v164 row_ror:8 row_mask:0xf bank_mask:0xf
    v_add_f32_dpp v165, v165, v165 row_ror:8 row_mask:0xf bank_mask:0xf
    v_add_f32_dpp v166, v166, v166 row_ror:8 row_mask:0xf bank_mask:0xf
    v_add_f32_dpp v167, v167, v167 row_ror:8 row_mask:0xf bank_mask:0xf
    v_mov_b32 v184, v160
    s_nop 1
    v_permlane16_swap_b32 v160, v184
    v_add_f32 v160, v160, v184
    v_mov_b32 v184, v161
    s_nop 1
    v_permlane16_swap_b32 v161, v184
    v_add_f32 v161, v161, v184
    v_mov_b32 v184, v162
    s_nop 1
    v_permlane16_swap_b32 v162, v184
    v_add_f32 v162, v162, v184
    v_mov_b32 v184, v163
    s_nop 1
    v_permlane16_swap_b32 v163, v184
    v_add_f32 v163, v163, v184
    v_mov_b32 v184, v164
    s_nop 1
    v_permlane16_swap_b32 v164, v184
    v_add_f32 v164, v164, v184
    v_mov_b32 v184, v165
    s_nop 1
    v_permlane16_swap_b32 v165, v184
    v_add_f32 v165, v165, v184
    v_mov_b32 v184, v166
    s_nop 1
    v_permlane16_swap_b32 v166, v184
    v_add_f32 v166, v166, v184
    v_mov_b32 v184, v167
    s_nop 1
    v_permlane16_swap_b32 v167, v184
    v_add_f32 v167, v167, v184
    v_mov_b32 v184, v160
    s_nop 1
    v_permlane32_swap_b32 v160, v184
    v_add_f32 v160, v160, v184
    v_mov_b32 v184, v161
    s_nop 1
    v_permlane32_swap_b32 v161, v184
    v_add_f32 v161, v161, v184
    v_mov_b32 v184, v162
    s_nop 1
    v_permlane32_swap_b32 v162, v184
    v_add_f32 v162, v162, v184
    v_mov_b32 v184, v163
    s_nop 1
    v_permlane32_swap_b32 v163, v184
    v_add_f32 v163, v163, v184
    v_mov_b32 v184, v164
    s_nop 1
    v_permlane32_swap_b32 v164, v184
    v_add_f32 v164, v164, v184
    v_mov_b32 v184, v165
    s_nop 1
    v_permlane32_swap_b32 v165, v184
    v_add_f32 v165, v165, v184
    v_mov_b32 v184, v166
    s_nop 1
    v_permlane32_swap_b32 v166, v184
    v_add_f32 v166, v166, v184
    v_mov_b32 v184, v167
    s_nop 1
    v_permlane32_swap_b32 v167, v184
    v_add_f32 v167, v167, v184
    ds_write_b128 v6, v[160:163] offset:0
    ds_write_b128 v6, v[164:167] offset:16
    s_waitcnt lgkmcnt(0)
    s_barrier
    ds_read_b128 v[192:195], v5 offset:0
    ds_read_b128 v[196:199], v5 offset:16
    ds_read_b128 v[200:203], v5 offset:256
    ds_read_b128 v[204:207], v5 offset:272
    ds_read_b128 v[208:211], v5 offset:512
    ds_read_b128 v[212:215], v5 offset:528
    ds_read_b128 v[216:219], v5 offset:768
    ds_read_b128 v[220:223], v5 offset:784
    ds_read_b128 v[224:227], v5 offset:1024
    ds_read_b128 v[228:231], v5 offset:1040
    ds_read_b128 v[232:235], v5 offset:1280
    ds_read_b128 v[236:239], v5 offset:1296
    ds_read_b128 v[240:243], v5 offset:1536
    ds_read_b128 v[244:247], v5 offset:1552
    ds_read_b128 v[248:251], v5 offset:1792
    ds_read_b128 v[252:255], v5 offset:1808
    s_waitcnt lgkmcnt(0)
    v_add_f32 v168, v192, v200
    v_add_f32 v169, v193, v201
    v_add_f32 v170, v194, v202
    v_add_f32 v171, v195, v203
    v_add_f32 v172, v196, v204
    v_add_f32 v173, v197, v205
    v_add_f32 v174, v198, v206
    v_add_f32 v175, v199, v207
    v_add_f32 v168, v168, v208
    v_add_f32 v169, v169, v209
    v_add_f32 v170, v170, v210
    v_add_f32 v171, v171, v211
    v_add_f32 v172, v172, v212
    v_add_f32 v173, v173, v213
    v_add_f32 v174, v174, v214
    v_add_f32 v175, v175, v215
    v_add_f32 v168, v168, v216
    v_add_f32 v169, v169, v217
    v_add_f32 v170, v170, v218
    v_add_f32 v171, v171, v219
    v_add_f32 v172, v172, v220
    v_add_f32 v173, v173, v221
    v_add_f32 v174, v174, v222
    v_add_f32 v175, v175, v223
    v_add_f32 v168, v168, v224
    v_add_f32 v169, v169, v225
    v_add_f32 v170, v170, v226
    v_add_f32 v171, v171, v227
    v_add_f32 v172, v172, v228
    v_add_f32 v173, v173, v229
    v_add_f32 v174, v174, v230
    v_add_f32 v175, v175, v231
    v_add_f32 v168, v168, v232
    v_add_f32 v169, v169, v233
    v_add_f32 v170, v170, v234
    v_add_f32 v171, v171, v235
    v_add_f32 v172, v172, v236
    v_add_f32 v173, v173, v237
    v_add_f32 v174, v174, v238
    v_add_f32 v175, v175, v239
    v_add_f32 v168, v168, v240
    v_add_f32 v169, v169, v241
    v_add_f32 v170, v170, v242
    v_add_f32 v171, v171, v243
    v_add_f32 v172, v172, v244
    v_add_f32 v173, v173, v245
    v_add_f32 v174, v174, v246
    v_add_f32 v175, v175, v247
    v_add_f32 v168, v168, v248
    v_add_f32 v169, v169, v249
    v_add_f32 v170, v170, v250
    v_add_f32 v171, v171, v251
    v_add_f32 v172, v172, v252
    v_add_f32 v173, v173, v253
    v_add_f32 v174, v174, v254
    v_add_f32 v175, v175, v255
    v_mul_f32 v168, 0x3aaaaaab, v168
    v_mul_f32 v169, 0x3aaaaaab, v169
    v_mul_f32 v170, 0x3aaaaaab, v170
    v_mul_f32 v171, 0x3aaaaaab, v171
    v_mul_f32 v172, 0x3aaaaaab, v172
    v_mul_f32 v173, 0x3aaaaaab, v173
    v_mul_f32 v174, 0x3aaaaaab, v174
    v_mul_f32 v175, 0x3aaaaaab, v175
    v_mov_b32 v160, 0
    v_mov_b32 v161, 0
    v_mov_b32 v162, 0
    v_mov_b32 v163, 0
    v_mov_b32 v164, 0
    v_mov_b32 v165, 0
    v_mov_b32 v166, 0
    v_mov_b32 v167, 0
    v_pk_add_f32 v[184:185], v[64:65], v[168:169] neg_lo:[0,1] neg_hi:[0,1]
    v_pk_add_f32 v[186:187], v[66:67], v[170:171] neg_lo:[0,1] neg_hi:[0,1]
    v_pk_add_f32 v[188:189], v[68:69], v[172:173] neg_lo:[0,1] neg_hi:[0,1]
    v_pk_add_f32 v[190:191], v[70:71], v[174:175] neg_lo:[0,1] neg_hi:[0,1]
    v_pk_fma_f32 v[160:161], v[184:185], v[184:185], v[160:161]
    v_pk_fma_f32 v[162:163], v[186:187], v[186:187], v[162:163]
    v_pk_fma_f32 v[164:165], v[188:189], v[188:189], v[164:165]
    v_pk_fma_f32 v[166:167], v[190:191], v[190:191], v[166:167]
    v_pk_add_f32 v[184:185], v[72:73], v[168:169] neg_lo:[0,1] neg_hi:[0,1]
    v_pk_add_f32 v[186:187], v[74:75], v[170:171] neg_lo:[0,1] neg_hi:[0,1]
    v_pk_add_f32 v[188:189], v[76:77], v[172:173] neg_lo:[0,1] neg_hi:[0,1]
    v_pk_add_f32 v[190:191], v[78:79], v[174:175] neg_lo:[0,1] neg_hi:[0,1]
    v_pk_fma_f32 v[160:161], v[184:185], v[184:185], v[160:161]
    v_pk_fma_f32 v[162:163], v[186:187], v[186:187], v[162:163]
    v_pk_fma_f32 v[164:165], v[188:189], v[188:189], v[164:165]
    v_pk_fma_f32 v[166:167], v[190:191], v[190:191], v[166:167]
    v_pk_add_f32 v[184:185], v[80:81], v[168:169] neg_lo:[0,1] neg_hi:[0,1]
    v_pk_add_f32 v[186:187], v[82:83], v[170:171] neg_lo:[0,1] neg_hi:[0,1]
    v_pk_add_f32 v[188:189], v[84:85], v[172:173] neg_lo:[0,1] neg_hi:[0,1]
    v_pk_add_f32 v[190:191], v[86:87], v[174:175] neg_lo:[0,1] neg_hi:[0,1]
    v_pk_fma_f32 v[160:161], v[184:185], v[184:185], v[160:161]
    v_pk_fma_f32 v[162:163], v[186:187], v[186:187], v[162:163]
    v_pk_fma_f32 v[164:165], v[188:189], v[188:189], v[164:165]
    v_pk_fma_f32 v[166:167], v[190:191], v[190:191], v[166:167]
    v_pk_add_f32 v[184:185], v[88:89], v[168:169] neg_lo:[0,1] neg_hi:[0,1]
    v_pk_add_f32 v[186:187], v[90:91], v[170:171] neg_lo:[0,1] neg_hi:[0,1]
    v_pk_add_f32 v[188:189], v[92:93], v[172:173] neg_lo:[0,1] neg_hi:[0,1]
    v_pk_add_f32 v[190:191], v[94:95], v[174:175] neg_lo:[0,1] neg_hi:[0,1]
    v_pk_fma_f32 v[160:161], v[184:185], v[184:185], v[160:161]
    v_pk_fma_f32 v[162:163], v[186:187], v[186:187], v[162:163]
    v_pk_fma_f32 v[164:165], v[188:189], v[188:189], v[164:165]
    v_pk_fma_f32 v[166:167], v[190:191], v[190:191], v[166:167]
    v_pk_add_f32 v[184:185], v[96:97], v[168:169] neg_lo:[0,1] neg_hi:[0,1]
    v_pk_add_f32 v[186:187], v[98:99], v[170:171] neg_lo:[0,1] neg_hi:[0,1]
    v_pk_add_f32 v[188:189], v[100:101], v[172:173] neg_lo:[0,1] neg_hi:[0,1]
    v_pk_add_f32 v[190:191], v[102:103], v[174:175] neg_lo:[0,1] neg_hi:[0,1]
    v_pk_fma_f32 v[160:161], v[184:185], v[184:185], v[160:161]
    v_pk_fma_f32 v[162:163], v[186:187], v[186:187], v[162:163]
    v_pk_fma_f32 v[164:165], v[188:189], v[188:189], v[164:165]
    v_pk_fma_f32 v[166:167], v[190:191], v[190:191], v[166:167]
    v_pk_add_f32 v[184:185], v[104:105], v[168:169] neg_lo:[0,1] neg_hi:[0,1]
    v_pk_add_f32 v[186:187], v[106:107], v[170:171] neg_lo:[0,1] neg_hi:[0,1]
    v_pk_add_f32 v[188:189], v[108:109], v[172:173] neg_lo:[0,1] neg_hi:[0,1]
    v_pk_add_f32 v[190:191], v[110:111], v[174:175] neg_lo:[0,1] neg_hi:[0,1]
    v_pk_fma_f32 v[160:161], v[184:185], v[184:185], v[160:161]
    v_pk_fma_f32 v[162:163], v[186:187], v[186:187], v[162:163]
    v_pk_fma_f32 v[164:165], v[188:189], v[188:189], v[164:165]
    v_pk_fma_f32 v[166:167], v[190:191], v[190:191], v[166:167]
    v_pk_add_f32 v[184:185], v[112:113], v[168:169] neg_lo:[0,1] neg_hi:[0,1]
    v_pk_add_f32 v[186:187], v[114:115], v[170:171] neg_lo:[0,1] neg_hi:[0,1]
    v_pk_add_f32 v[188:189], v[116:117], v[172:173] neg_lo:[0,1] neg_hi:[0,1]
    v_pk_add_f32 v[190:191], v[118:119], v[174:175] neg_lo:[0,1] neg_hi:[0,1]
    v_pk_fma_f32 v[160:161], v[184:185], v[184:185], v[160:161]
    v_pk_fma_f32 v[162:163], v[186:187], v[186:187], v[162:163]
    v_pk_fma_f32 v[164:165], v[188:189], v[188:189], v[164:165]
    v_pk_fma_f32 v[166:167], v[190:191], v[190:191], v[166:167]
    v_pk_add_f32 v[184:185], v[120:121], v[168:169] neg_lo:[0,1] neg_hi:[0,1]
    v_pk_add_f32 v[186:187], v[122:123], v[170:171] neg_lo:[0,1] neg_hi:[0,1]
    v_pk_add_f32 v[188:189], v[124:125], v[172:173] neg_lo:[0,1] neg_hi:[0,1]
    v_pk_add_f32 v[190:191], v[126:127], v[174:175] neg_lo:[0,1] neg_hi:[0,1]
    v_pk_fma_f32 v[160:161], v[184:185], v[184:185], v[160:161]
    v_pk_fma_f32 v[162:163], v[186:187], v[186:187], v[162:163]
    v_pk_fma_f32 v[164:165], v[188:189], v[188:189], v[164:165]
    v_pk_fma_f32 v[166:167], v[190:191], v[190:191], v[166:167]
    v_pk_add_f32 v[184:185], v[128:129], v[168:169] neg_lo:[0,1] neg_hi:[0,1]
    v_pk_add_f32 v[186:187], v[130:131], v[170:171] neg_lo:[0,1] neg_hi:[0,1]
    v_pk_add_f32 v[188:189], v[132:133], v[172:173] neg_lo:[0,1] neg_hi:[0,1]
    v_pk_add_f32 v[190:191], v[134:135], v[174:175] neg_lo:[0,1] neg_hi:[0,1]
    v_pk_fma_f32 v[160:161], v[184:185], v[184:185], v[160:161]
    v_pk_fma_f32 v[162:163], v[186:187], v[186:187], v[162:163]
    v_pk_fma_f32 v[164:165], v[188:189], v[188:189], v[164:165]
    v_pk_fma_f32 v[166:167], v[190:191], v[190:191], v[166:167]
    v_pk_add_f32 v[184:185], v[136:137], v[168:169] neg_lo:[0,1] neg_hi:[0,1]
    v_pk_add_f32 v[186:187], v[138:139], v[170:171] neg_lo:[0,1] neg_hi:[0,1]
    v_pk_add_f32 v[188:189], v[140:141], v[172:173] neg_lo:[0,1] neg_hi:[0,1]
    v_pk_add_f32 v[190:191], v[142:143], v[174:175] neg_lo:[0,1] neg_hi:[0,1]
    v_pk_fma_f32 v[160:161], v[184:185], v[184:185], v[160:161]
    v_pk_fma_f32 v[162:163], v[186:187], v[186:187], v[162:163]
    v_pk_fma_f32 v[164:165], v[188:189], v[188:189], v[164:165]
    v_pk_fma_f32 v[166:167], v[190:191], v[190:191], v[166:167]
    v_pk_add_f32 v[184:185], v[144:145], v[168:169] neg_lo:[0,1] neg_hi:[0,1]
    v_pk_add_f32 v[186:187], v[146:147], v[170:171] neg_lo:[0,1] neg_hi:[0,1]
    v_pk_add_f32 v[188:189], v[148:149], v[172:173] neg_lo:[0,1] neg_hi:[0,1]
    v_pk_add_f32 v[190:191], v[150:151], v[174:175] neg_lo:[0,1] neg_hi:[0,1]
    v_pk_fma_f32 v[160:161], v[184:185], v[184:185], v[160:161]
    v_pk_fma_f32 v[162:163], v[186:187], v[186:187], v[162:163]
    v_pk_fma_f32 v[164:165], v[188:189], v[188:189], v[164:165]
    v_pk_fma_f32 v[166:167], v[190:191], v[190:191], v[166:167]
    v_pk_add_f32 v[184:185], v[152:153], v[168:169] neg_lo:[0,1] neg_hi:[0,1]
    v_pk_add_f32 v[186:187], v[154:155], v[170:171] neg_lo:[0,1] neg_hi:[0,1]
    v_pk_add_f32 v[188:189], v[156:157], v[172:173] neg_lo:[0,1] neg_hi:[0,1]
    v_pk_add_f32 v[190:191], v[158:159], v[174:175] neg_lo:[0,1] neg_hi:[0,1]
    v_pk_fma_f32 v[160:161], v[184:185], v[184:185], v[160:161]
    v_pk_fma_f32 v[162:163], v[186:187], v[186:187], v[162:163]
    v_pk_fma_f32 v[164:165], v[188:189], v[188:189], v[164:165]
    v_pk_fma_f32 v[166:167], v[190:191], v[190:191], v[166:167]
    v_add_f32_dpp v160, v160, v160 row_ror:8 row_mask:0xf bank_mask:0xf
    v_add_f32_dpp v161, v161, v161 row_ror:8 row_mask:0xf bank_mask:0xf
    v_add_f32_dpp v162, v162, v162 row_ror:8 row_mask:0xf bank_mask:0xf
    v_add_f32_dpp v163, v163, v163 row_ror:8 row_mask:0xf bank_mask:0xf
    v_add_f32_dpp v164, v164, v164 row_ror:8 row_mask:0xf bank_mask:0xf
    v_add_f32_dpp v165, v165, v165 row_ror:8 row_mask:0xf bank_mask:0xf
    v_add_f32_dpp v166, v166, v166 row_ror:8 row_mask:0xf bank_mask:0xf
    v_add_f32_dpp v167, v167, v167 row_ror:8 row_mask:0xf bank_mask:0xf
    v_mov_b32 v184, v160
    s_nop 1
    v_permlane16_swap_b32 v160, v184
    v_add_f32 v160, v160, v184
    v_mov_b32 v184, v161
    s_nop 1
    v_permlane16_swap_b32 v161, v184
    v_add_f32 v161, v161, v184
    v_mov_b32 v184, v162
    s_nop 1
    v_permlane16_swap_b32 v162, v184
    v_add_f32 v162, v162, v184
    v_mov_b32 v184, v163
    s_nop 1
    v_permlane16_swap_b32 v163, v184
    v_add_f32 v163, v163, v184
    v_mov_b32 v184, v164
    s_nop 1
    v_permlane16_swap_b32 v164, v184
    v_add_f32 v164, v164, v184
    v_mov_b32 v184, v165
    s_nop 1
    v_permlane16_swap_b32 v165, v184
    v_add_f32 v165, v165, v184
    v_mov_b32 v184, v166
    s_nop 1
    v_permlane16_swap_b32 v166, v184
    v_add_f32 v166, v166, v184
    v_mov_b32 v184, v167
    s_nop 1
    v_permlane16_swap_b32 v167, v184
    v_add_f32 v167, v167, v184
    v_mov_b32 v184, v160
    s_nop 1
    v_permlane32_swap_b32 v160, v184
    v_add_f32 v160, v160, v184
    v_mov_b32 v184, v161
    s_nop 1
    v_permlane32_swap_b32 v161, v184
    v_add_f32 v161, v161, v184
    v_mov_b32 v184, v162
    s_nop 1
    v_permlane32_swap_b32 v162, v184
    v_add_f32 v162, v162, v184
    v_mov_b32 v184, v163
    s_nop 1
    v_permlane32_swap_b32 v163, v184
    v_add_f32 v163, v163, v184
    v_mov_b32 v184, v164
    s_nop 1
    v_permlane32_swap_b32 v164, v184
    v_add_f32 v164, v164, v184
    v_mov_b32 v184, v165
    s_nop 1
    v_permlane32_swap_b32 v165, v184
    v_add_f32 v165, v165, v184
    v_mov_b32 v184, v166
    s_nop 1
    v_permlane32_swap_b32 v166, v184
    v_add_f32 v166, v166, v184
    v_mov_b32 v184, v167
    s_nop 1
    v_permlane32_swap_b32 v167, v184
    v_add_f32 v167, v167, v184
    ds_write_b128 v6, v[160:163] offset:4096
    ds_write_b128 v6, v[164:167] offset:4112
    s_waitcnt lgkmcnt(0)
    s_barrier
    ds_read_b128 v[192:195], v5 offset:4096
    ds_read_b128 v[196:199], v5 offset:4112
    ds_read_b128 v[200:203], v5 offset:4352
    ds_read_b128 v[204:207], v5 offset:4368
    ds_read_b128 v[208:211], v5 offset:4608
    ds_read_b128 v[212:215], v5 offset:4624
    ds_read_b128 v[216:219], v5 offset:4864
    ds_read_b128 v[220:223], v5 offset:4880
    ds_read_b128 v[224:227], v5 offset:5120
    ds_read_b128 v[228:231], v5 offset:5136
    ds_read_b128 v[232:235], v5 offset:5376
    ds_read_b128 v[236:239], v5 offset:5392
    ds_read_b128 v[240:243], v5 offset:5632
    ds_read_b128 v[244:247], v5 offset:5648
    ds_read_b128 v[248:251], v5 offset:5888
    ds_read_b128 v[252:255], v5 offset:5904
    s_waitcnt lgkmcnt(0)
    v_add_f32 v176, v192, v200
    v_add_f32 v177, v193, v201
    v_add_f32 v178, v194, v202
    v_add_f32 v179, v195, v203
    v_add_f32 v180, v196, v204
    v_add_f32 v181, v197, v205
    v_add_f32 v182, v198, v206
    v_add_f32 v183, v199, v207
    v_add_f32 v176, v176, v208
    v_add_f32 v177, v177, v209
    v_add_f32 v178, v178, v210
    v_add_f32 v179, v179, v211
    v_add_f32 v180, v180, v212
    v_add_f32 v181, v181, v213
    v_add_f32 v182, v182, v214
    v_add_f32 v183, v183, v215
    v_add_f32 v176, v176, v216
    v_add_f32 v177, v177, v217
    v_add_f32 v178, v178, v218
    v_add_f32 v179, v179, v219
    v_add_f32 v180, v180, v220
    v_add_f32 v181, v181, v221
    v_add_f32 v182, v182, v222
    v_add_f32 v183, v183, v223
    v_add_f32 v176, v176, v224
    v_add_f32 v177, v177, v225
    v_add_f32 v178, v178, v226
    v_add_f32 v179, v179, v227
    v_add_f32 v180, v180, v228
    v_add_f32 v181, v181, v229
    v_add_f32 v182, v182, v230
    v_add_f32 v183, v183, v231
    v_add_f32 v176, v176, v232
    v_add_f32 v177, v177, v233
    v_add_f32 v178, v178, v234
    v_add_f32 v179, v179, v235
    v_add_f32 v180, v180, v236
    v_add_f32 v181, v181, v237
    v_add_f32 v182, v182, v238
    v_add_f32 v183, v183, v239
    v_add_f32 v176, v176, v240
    v_add_f32 v177, v177, v241
    v_add_f32 v178, v178, v242
    v_add_f32 v179, v179, v243
    v_add_f32 v180, v180, v244
    v_add_f32 v181, v181, v245
    v_add_f32 v182, v182, v246
    v_add_f32 v183, v183, v247
    v_add_f32 v176, v176, v248
    v_add_f32 v177, v177, v249
    v_add_f32 v178, v178, v250
    v_add_f32 v179, v179, v251
    v_add_f32 v180, v180, v252
    v_add_f32 v181, v181, v253
    v_add_f32 v182, v182, v254
    v_add_f32 v183, v183, v255
    v_mul_f32 v176, 0x3aaaaaab, v176
    v_mul_f32 v177, 0x3aaaaaab, v177
    v_mul_f32 v178, 0x3aaaaaab, v178
    v_mul_f32 v179, 0x3aaaaaab, v179
    v_mul_f32 v180, 0x3aaaaaab, v180
    v_mul_f32 v181, 0x3aaaaaab, v181
    v_mul_f32 v182, 0x3aaaaaab, v182
    v_mul_f32 v183, 0x3aaaaaab, v183
    v_cvt_pk_bf16_f32 v184, v168, v176
    v_lshlrev_b32 v168, 16, v184
    v_and_b32 v176, 0xffff0000, v184
    v_cvt_pk_bf16_f32 v184, v169, v177
    v_lshlrev_b32 v169, 16, v184
    v_and_b32 v177, 0xffff0000, v184
    v_cvt_pk_bf16_f32 v184, v170, v178
    v_lshlrev_b32 v170, 16, v184
    v_and_b32 v178, 0xffff0000, v184
    v_cvt_pk_bf16_f32 v184, v171, v179
    v_lshlrev_b32 v171, 16, v184
    v_and_b32 v179, 0xffff0000, v184
    v_cvt_pk_bf16_f32 v184, v172, v180
    v_lshlrev_b32 v172, 16, v184
    v_and_b32 v180, 0xffff0000, v184
    v_cvt_pk_bf16_f32 v184, v173, v181
    v_lshlrev_b32 v173, 16, v184
    v_and_b32 v181, 0xffff0000, v184
    v_cvt_pk_bf16_f32 v184, v174, v182
    v_lshlrev_b32 v174, 16, v184
    v_and_b32 v182, 0xffff0000, v184
    v_cvt_pk_bf16_f32 v184, v175, v183
    v_lshlrev_b32 v175, 16, v184
    v_and_b32 v183, 0xffff0000, v184
    v_add_f32 v176, 0x3727c5ac, v176
    v_add_f32 v177, 0x3727c5ac, v177
    v_add_f32 v178, 0x3727c5ac, v178
    v_add_f32 v179, 0x3727c5ac, v179
    v_add_f32 v180, 0x3727c5ac, v180
    v_add_f32 v181, 0x3727c5ac, v181
    v_add_f32 v182, 0x3727c5ac, v182
    v_add_f32 v183, 0x3727c5ac, v183
    v_cvt_pk_bf16_f32 v184, v176, v177
    v_lshlrev_b32 v176, 16, v184
    v_and_b32 v177, 0xffff0000, v184
    v_cvt_pk_bf16_f32 v184, v178, v179
    v_lshlrev_b32 v178, 16, v184
    v_and_b32 v179, 0xffff0000, v184
    v_cvt_pk_bf16_f32 v184, v180, v181
    v_lshlrev_b32 v180, 16, v184
    v_and_b32 v181, 0xffff0000, v184
    v_cvt_pk_bf16_f32 v184, v182, v183
    v_lshlrev_b32 v182, 16, v184
    v_and_b32 v183, 0xffff0000, v184
    v_sqrt_f32 v176, v176
    v_sqrt_f32 v177, v177
    v_sqrt_f32 v178, v178
    v_sqrt_f32 v179, v179
    v_sqrt_f32 v180, v180
    v_sqrt_f32 v181, v181
    v_sqrt_f32 v182, v182
    v_sqrt_f32 v183, v183
    v_cvt_pk_bf16_f32 v184, v176, v177
    v_lshlrev_b32 v176, 16, v184
    v_and_b32 v177, 0xffff0000, v184
    v_cvt_pk_bf16_f32 v184, v178, v179
    v_lshlrev_b32 v178, 16, v184
    v_and_b32 v179, 0xffff0000, v184
    v_cvt_pk_bf16_f32 v184, v180, v181
    v_lshlrev_b32 v180, 16, v184
    v_and_b32 v181, 0xffff0000, v184
    v_cvt_pk_bf16_f32 v184, v182, v183
    v_lshlrev_b32 v182, 16, v184
    v_and_b32 v183, 0xffff0000, v184
    v_rcp_f32 v176, v176
    v_rcp_f32 v177, v177
    v_rcp_f32 v178, v178
    v_rcp_f32 v179, v179
    v_rcp_f32 v180, v180
    v_rcp_f32 v181, v181
    v_rcp_f32 v182, v182
    v_rcp_f32 v183, v183
    v_pk_add_f32 v[64:65], v[64:65], v[168:169] neg_lo:[0,1] neg_hi:[0,1]
    v_pk_add_f32 v[66:67], v[66:67], v[170:171] neg_lo:[0,1] neg_hi:[0,1]
    v_pk_add_f32 v[68:69], v[68:69], v[172:173] neg_lo:[0,1] neg_hi:[0,1]
    v_pk_add_f32 v[70:71], v[70:71], v[174:175] neg_lo:[0,1] neg_hi:[0,1]
    v_cvt_pk_bf16_f32 v184, v64, v65
    v_lshlrev_b32 v64, 16, v184
    v_and_b32 v65, 0xffff0000, v184
    v_cvt_pk_bf16_f32 v185, v66, v67
    v_lshlrev_b32 v66, 16, v185
    v_and_b32 v67, 0xffff0000, v185
    v_cvt_pk_bf16_f32 v186, v68, v69
    v_lshlrev_b32 v68, 16, v186
    v_and_b32 v69, 0xffff0000, v186
    v_cvt_pk_bf16_f32 v187, v70, v71
    v_lshlrev_b32 v70, 16, v187
    v_and_b32 v71, 0xffff0000, v187
    v_pk_mul_f32 v[64:65], v[64:65], v[176:177]
    v_pk_mul_f32 v[66:67], v[66:67], v[178:179]
    v_pk_mul_f32 v[68:69], v[68:69], v[180:181]
    v_pk_mul_f32 v[70:71], v[70:71], v[182:183]
    v_cvt_pk_bf16_f32 v16, v64, v65
    v_cvt_pk_bf16_f32 v17, v66, v67
    v_cvt_pk_bf16_f32 v18, v68, v69
    v_cvt_pk_bf16_f32 v19, v70, v71
    s_add_u32 s34, s35, 0
    buffer_store_dwordx4 v[16:19], v7, s[20:23], s34 offen offset:0
    v_pk_add_f32 v[72:73], v[72:73], v[168:169] neg_lo:[0,1] neg_hi:[0,1]
    v_pk_add_f32 v[74:75], v[74:75], v[170:171] neg_lo:[0,1] neg_hi:[0,1]
    v_pk_add_f32 v[76:77], v[76:77], v[172:173] neg_lo:[0,1] neg_hi:[0,1]
    v_pk_add_f32 v[78:79], v[78:79], v[174:175] neg_lo:[0,1] neg_hi:[0,1]
    v_cvt_pk_bf16_f32 v184, v72, v73
    v_lshlrev_b32 v72, 16, v184
    v_and_b32 v73, 0xffff0000, v184
    v_cvt_pk_bf16_f32 v185, v74, v75
    v_lshlrev_b32 v74, 16, v185
    v_and_b32 v75, 0xffff0000, v185
    v_cvt_pk_bf16_f32 v186, v76, v77
    v_lshlrev_b32 v76, 16, v186
    v_and_b32 v77, 0xffff0000, v186
    v_cvt_pk_bf16_f32 v187, v78, v79
    v_lshlrev_b32 v78, 16, v187
    v_and_b32 v79, 0xffff0000, v187
    v_pk_mul_f32 v[72:73], v[72:73], v[176:177]
    v_pk_mul_f32 v[74:75], v[74:75], v[178:179]
    v_pk_mul_f32 v[76:77], v[76:77], v[180:181]
    v_pk_mul_f32 v[78:79], v[78:79], v[182:183]
    v_cvt_pk_bf16_f32 v20, v72, v73
    v_cvt_pk_bf16_f32 v21, v74, v75
    v_cvt_pk_bf16_f32 v22, v76, v77
    v_cvt_pk_bf16_f32 v23, v78, v79
    s_add_u32 s34, s35, 0
    buffer_store_dwordx4 v[20:23], v7, s[20:23], s34 offen offset:128
    v_pk_add_f32 v[80:81], v[80:81], v[168:169] neg_lo:[0,1] neg_hi:[0,1]
    v_pk_add_f32 v[82:83], v[82:83], v[170:171] neg_lo:[0,1] neg_hi:[0,1]
    v_pk_add_f32 v[84:85], v[84:85], v[172:173] neg_lo:[0,1] neg_hi:[0,1]
    v_pk_add_f32 v[86:87], v[86:87], v[174:175] neg_lo:[0,1] neg_hi:[0,1]
    v_cvt_pk_bf16_f32 v184, v80, v81
    v_lshlrev_b32 v80, 16, v184
    v_and_b32 v81, 0xffff0000, v184
    v_cvt_pk_bf16_f32 v185, v82, v83
    v_lshlrev_b32 v82, 16, v185
    v_and_b32 v83, 0xffff0000, v185
    v_cvt_pk_bf16_f32 v186, v84, v85
    v_lshlrev_b32 v84, 16, v186
    v_and_b32 v85, 0xffff0000, v186
    v_cvt_pk_bf16_f32 v187, v86, v87
    v_lshlrev_b32 v86, 16, v187
    v_and_b32 v87, 0xffff0000, v187
    v_pk_mul_f32 v[80:81], v[80:81], v[176:177]
    v_pk_mul_f32 v[82:83], v[82:83], v[178:179]
    v_pk_mul_f32 v[84:85], v[84:85], v[180:181]
    v_pk_mul_f32 v[86:87], v[86:87], v[182:183]
    v_cvt_pk_bf16_f32 v24, v80, v81
    v_cvt_pk_bf16_f32 v25, v82, v83
    v_cvt_pk_bf16_f32 v26, v84, v85
    v_cvt_pk_bf16_f32 v27, v86, v87
    s_add_u32 s34, s35, 65536
    buffer_store_dwordx4 v[24:27], v7, s[20:23], s34 offen offset:0
    v_pk_add_f32 v[88:89], v[88:89], v[168:169] neg_lo:[0,1] neg_hi:[0,1]
    v_pk_add_f32 v[90:91], v[90:91], v[170:171] neg_lo:[0,1] neg_hi:[0,1]
    v_pk_add_f32 v[92:93], v[92:93], v[172:173] neg_lo:[0,1] neg_hi:[0,1]
    v_pk_add_f32 v[94:95], v[94:95], v[174:175] neg_lo:[0,1] neg_hi:[0,1]
    v_cvt_pk_bf16_f32 v184, v88, v89
    v_lshlrev_b32 v88, 16, v184
    v_and_b32 v89, 0xffff0000, v184
    v_cvt_pk_bf16_f32 v185, v90, v91
    v_lshlrev_b32 v90, 16, v185
    v_and_b32 v91, 0xffff0000, v185
    v_cvt_pk_bf16_f32 v186, v92, v93
    v_lshlrev_b32 v92, 16, v186
    v_and_b32 v93, 0xffff0000, v186
    v_cvt_pk_bf16_f32 v187, v94, v95
    v_lshlrev_b32 v94, 16, v187
    v_and_b32 v95, 0xffff0000, v187
    v_pk_mul_f32 v[88:89], v[88:89], v[176:177]
    v_pk_mul_f32 v[90:91], v[90:91], v[178:179]
    v_pk_mul_f32 v[92:93], v[92:93], v[180:181]
    v_pk_mul_f32 v[94:95], v[94:95], v[182:183]
    v_cvt_pk_bf16_f32 v28, v88, v89
    v_cvt_pk_bf16_f32 v29, v90, v91
    v_cvt_pk_bf16_f32 v30, v92, v93
    v_cvt_pk_bf16_f32 v31, v94, v95
    s_add_u32 s34, s35, 65536
    buffer_store_dwordx4 v[28:31], v7, s[20:23], s34 offen offset:128
    v_pk_add_f32 v[96:97], v[96:97], v[168:169] neg_lo:[0,1] neg_hi:[0,1]
    v_pk_add_f32 v[98:99], v[98:99], v[170:171] neg_lo:[0,1] neg_hi:[0,1]
    v_pk_add_f32 v[100:101], v[100:101], v[172:173] neg_lo:[0,1] neg_hi:[0,1]
    v_pk_add_f32 v[102:103], v[102:103], v[174:175] neg_lo:[0,1] neg_hi:[0,1]
    v_cvt_pk_bf16_f32 v184, v96, v97
    v_lshlrev_b32 v96, 16, v184
    v_and_b32 v97, 0xffff0000, v184
    v_cvt_pk_bf16_f32 v185, v98, v99
    v_lshlrev_b32 v98, 16, v185
    v_and_b32 v99, 0xffff0000, v185
    v_cvt_pk_bf16_f32 v186, v100, v101
    v_lshlrev_b32 v100, 16, v186
    v_and_b32 v101, 0xffff0000, v186
    v_cvt_pk_bf16_f32 v187, v102, v103
    v_lshlrev_b32 v102, 16, v187
    v_and_b32 v103, 0xffff0000, v187
    v_pk_mul_f32 v[96:97], v[96:97], v[176:177]
    v_pk_mul_f32 v[98:99], v[98:99], v[178:179]
    v_pk_mul_f32 v[100:101], v[100:101], v[180:181]
    v_pk_mul_f32 v[102:103], v[102:103], v[182:183]
    v_cvt_pk_bf16_f32 v32, v96, v97
    v_cvt_pk_bf16_f32 v33, v98, v99
    v_cvt_pk_bf16_f32 v34, v100, v101
    v_cvt_pk_bf16_f32 v35, v102, v103
    s_add_u32 s34, s35, 131072
    buffer_store_dwordx4 v[32:35], v7, s[20:23], s34 offen offset:0
    v_pk_add_f32 v[104:105], v[104:105], v[168:169] neg_lo:[0,1] neg_hi:[0,1]
    v_pk_add_f32 v[106:107], v[106:107], v[170:171] neg_lo:[0,1] neg_hi:[0,1]
    v_pk_add_f32 v[108:109], v[108:109], v[172:173] neg_lo:[0,1] neg_hi:[0,1]
    v_pk_add_f32 v[110:111], v[110:111], v[174:175] neg_lo:[0,1] neg_hi:[0,1]
    v_cvt_pk_bf16_f32 v184, v104, v105
    v_lshlrev_b32 v104, 16, v184
    v_and_b32 v105, 0xffff0000, v184
    v_cvt_pk_bf16_f32 v185, v106, v107
    v_lshlrev_b32 v106, 16, v185
    v_and_b32 v107, 0xffff0000, v185
    v_cvt_pk_bf16_f32 v186, v108, v109
    v_lshlrev_b32 v108, 16, v186
    v_and_b32 v109, 0xffff0000, v186
    v_cvt_pk_bf16_f32 v187, v110, v111
    v_lshlrev_b32 v110, 16, v187
    v_and_b32 v111, 0xffff0000, v187
    v_pk_mul_f32 v[104:105], v[104:105], v[176:177]
    v_pk_mul_f32 v[106:107], v[106:107], v[178:179]
    v_pk_mul_f32 v[108:109], v[108:109], v[180:181]
    v_pk_mul_f32 v[110:111], v[110:111], v[182:183]
    v_cvt_pk_bf16_f32 v36, v104, v105
    v_cvt_pk_bf16_f32 v37, v106, v107
    v_cvt_pk_bf16_f32 v38, v108, v109
    v_cvt_pk_bf16_f32 v39, v110, v111
    s_add_u32 s34, s35, 131072
    buffer_store_dwordx4 v[36:39], v7, s[20:23], s34 offen offset:128
    v_pk_add_f32 v[112:113], v[112:113], v[168:169] neg_lo:[0,1] neg_hi:[0,1]
    v_pk_add_f32 v[114:115], v[114:115], v[170:171] neg_lo:[0,1] neg_hi:[0,1]
    v_pk_add_f32 v[116:117], v[116:117], v[172:173] neg_lo:[0,1] neg_hi:[0,1]
    v_pk_add_f32 v[118:119], v[118:119], v[174:175] neg_lo:[0,1] neg_hi:[0,1]
    v_cvt_pk_bf16_f32 v184, v112, v113
    v_lshlrev_b32 v112, 16, v184
    v_and_b32 v113, 0xffff0000, v184
    v_cvt_pk_bf16_f32 v185, v114, v115
    v_lshlrev_b32 v114, 16, v185
    v_and_b32 v115, 0xffff0000, v185
    v_cvt_pk_bf16_f32 v186, v116, v117
    v_lshlrev_b32 v116, 16, v186
    v_and_b32 v117, 0xffff0000, v186
    v_cvt_pk_bf16_f32 v187, v118, v119
    v_lshlrev_b32 v118, 16, v187
    v_and_b32 v119, 0xffff0000, v187
    v_pk_mul_f32 v[112:113], v[112:113], v[176:177]
    v_pk_mul_f32 v[114:115], v[114:115], v[178:179]
    v_pk_mul_f32 v[116:117], v[116:117], v[180:181]
    v_pk_mul_f32 v[118:119], v[118:119], v[182:183]
    v_cvt_pk_bf16_f32 v40, v112, v113
    v_cvt_pk_bf16_f32 v41, v114, v115
    v_cvt_pk_bf16_f32 v42, v116, v117
    v_cvt_pk_bf16_f32 v43, v118, v119
    s_add_u32 s34, s35, 196608
    buffer_store_dwordx4 v[40:43], v7, s[20:23], s34 offen offset:0
    v_pk_add_f32 v[120:121], v[120:121], v[168:169] neg_lo:[0,1] neg_hi:[0,1]
    v_pk_add_f32 v[122:123], v[122:123], v[170:171] neg_lo:[0,1] neg_hi:[0,1]
    v_pk_add_f32 v[124:125], v[124:125], v[172:173] neg_lo:[0,1] neg_hi:[0,1]
    v_pk_add_f32 v[126:127], v[126:127], v[174:175] neg_lo:[0,1] neg_hi:[0,1]
    v_cvt_pk_bf16_f32 v184, v120, v121
    v_lshlrev_b32 v120, 16, v184
    v_and_b32 v121, 0xffff0000, v184
    v_cvt_pk_bf16_f32 v185, v122, v123
    v_lshlrev_b32 v122, 16, v185
    v_and_b32 v123, 0xffff0000, v185
    v_cvt_pk_bf16_f32 v186, v124, v125
    v_lshlrev_b32 v124, 16, v186
    v_and_b32 v125, 0xffff0000, v186
    v_cvt_pk_bf16_f32 v187, v126, v127
    v_lshlrev_b32 v126, 16, v187
    v_and_b32 v127, 0xffff0000, v187
    v_pk_mul_f32 v[120:121], v[120:121], v[176:177]
    v_pk_mul_f32 v[122:123], v[122:123], v[178:179]
    v_pk_mul_f32 v[124:125], v[124:125], v[180:181]
    v_pk_mul_f32 v[126:127], v[126:127], v[182:183]
    v_cvt_pk_bf16_f32 v44, v120, v121
    v_cvt_pk_bf16_f32 v45, v122, v123
    v_cvt_pk_bf16_f32 v46, v124, v125
    v_cvt_pk_bf16_f32 v47, v126, v127
    s_add_u32 s34, s35, 196608
    buffer_store_dwordx4 v[44:47], v7, s[20:23], s34 offen offset:128
    v_pk_add_f32 v[128:129], v[128:129], v[168:169] neg_lo:[0,1] neg_hi:[0,1]
    v_pk_add_f32 v[130:131], v[130:131], v[170:171] neg_lo:[0,1] neg_hi:[0,1]
    v_pk_add_f32 v[132:133], v[132:133], v[172:173] neg_lo:[0,1] neg_hi:[0,1]
    v_pk_add_f32 v[134:135], v[134:135], v[174:175] neg_lo:[0,1] neg_hi:[0,1]
    v_cvt_pk_bf16_f32 v184, v128, v129
    v_lshlrev_b32 v128, 16, v184
    v_and_b32 v129, 0xffff0000, v184
    v_cvt_pk_bf16_f32 v185, v130, v131
    v_lshlrev_b32 v130, 16, v185
    v_and_b32 v131, 0xffff0000, v185
    v_cvt_pk_bf16_f32 v186, v132, v133
    v_lshlrev_b32 v132, 16, v186
    v_and_b32 v133, 0xffff0000, v186
    v_cvt_pk_bf16_f32 v187, v134, v135
    v_lshlrev_b32 v134, 16, v187
    v_and_b32 v135, 0xffff0000, v187
    v_pk_mul_f32 v[128:129], v[128:129], v[176:177]
    v_pk_mul_f32 v[130:131], v[130:131], v[178:179]
    v_pk_mul_f32 v[132:133], v[132:133], v[180:181]
    v_pk_mul_f32 v[134:135], v[134:135], v[182:183]
    v_cvt_pk_bf16_f32 v48, v128, v129
    v_cvt_pk_bf16_f32 v49, v130, v131
    v_cvt_pk_bf16_f32 v50, v132, v133
    v_cvt_pk_bf16_f32 v51, v134, v135
    s_add_u32 s34, s35, 262144
    buffer_store_dwordx4 v[48:51], v7, s[20:23], s34 offen offset:0
    v_pk_add_f32 v[136:137], v[136:137], v[168:169] neg_lo:[0,1] neg_hi:[0,1]
    v_pk_add_f32 v[138:139], v[138:139], v[170:171] neg_lo:[0,1] neg_hi:[0,1]
    v_pk_add_f32 v[140:141], v[140:141], v[172:173] neg_lo:[0,1] neg_hi:[0,1]
    v_pk_add_f32 v[142:143], v[142:143], v[174:175] neg_lo:[0,1] neg_hi:[0,1]
    v_cvt_pk_bf16_f32 v184, v136, v137
    v_lshlrev_b32 v136, 16, v184
    v_and_b32 v137, 0xffff0000, v184
    v_cvt_pk_bf16_f32 v185, v138, v139
    v_lshlrev_b32 v138, 16, v185
    v_and_b32 v139, 0xffff0000, v185
    v_cvt_pk_bf16_f32 v186, v140, v141
    v_lshlrev_b32 v140, 16, v186
    v_and_b32 v141, 0xffff0000, v186
    v_cvt_pk_bf16_f32 v187, v142, v143
    v_lshlrev_b32 v142, 16, v187
    v_and_b32 v143, 0xffff0000, v187
    v_pk_mul_f32 v[136:137], v[136:137], v[176:177]
    v_pk_mul_f32 v[138:139], v[138:139], v[178:179]
    v_pk_mul_f32 v[140:141], v[140:141], v[180:181]
    v_pk_mul_f32 v[142:143], v[142:143], v[182:183]
    v_cvt_pk_bf16_f32 v52, v136, v137
    v_cvt_pk_bf16_f32 v53, v138, v139
    v_cvt_pk_bf16_f32 v54, v140, v141
    v_cvt_pk_bf16_f32 v55, v142, v143
    s_add_u32 s34, s35, 262144
    buffer_store_dwordx4 v[52:55], v7, s[20:23], s34 offen offset:128
    v_pk_add_f32 v[144:145], v[144:145], v[168:169] neg_lo:[0,1] neg_hi:[0,1]
    v_pk_add_f32 v[146:147], v[146:147], v[170:171] neg_lo:[0,1] neg_hi:[0,1]
    v_pk_add_f32 v[148:149], v[148:149], v[172:173] neg_lo:[0,1] neg_hi:[0,1]
    v_pk_add_f32 v[150:151], v[150:151], v[174:175] neg_lo:[0,1] neg_hi:[0,1]
    v_cvt_pk_bf16_f32 v184, v144, v145
    v_lshlrev_b32 v144, 16, v184
    v_and_b32 v145, 0xffff0000, v184
    v_cvt_pk_bf16_f32 v185, v146, v147
    v_lshlrev_b32 v146, 16, v185
    v_and_b32 v147, 0xffff0000, v185
    v_cvt_pk_bf16_f32 v186, v148, v149
    v_lshlrev_b32 v148, 16, v186
    v_and_b32 v149, 0xffff0000, v186
    v_cvt_pk_bf16_f32 v187, v150, v151
    v_lshlrev_b32 v150, 16, v187
    v_and_b32 v151, 0xffff0000, v187
    v_pk_mul_f32 v[144:145], v[144:145], v[176:177]
    v_pk_mul_f32 v[146:147], v[146:147], v[178:179]
    v_pk_mul_f32 v[148:149], v[148:149], v[180:181]
    v_pk_mul_f32 v[150:151], v[150:151], v[182:183]
    v_cvt_pk_bf16_f32 v56, v144, v145
    v_cvt_pk_bf16_f32 v57, v146, v147
    v_cvt_pk_bf16_f32 v58, v148, v149
    v_cvt_pk_bf16_f32 v59, v150, v151
    s_add_u32 s34, s35, 327680
    buffer_store_dwordx4 v[56:59], v7, s[20:23], s34 offen offset:0
    v_pk_add_f32 v[152:153], v[152:153], v[168:169] neg_lo:[0,1] neg_hi:[0,1]
    v_pk_add_f32 v[154:155], v[154:155], v[170:171] neg_lo:[0,1] neg_hi:[0,1]
    v_pk_add_f32 v[156:157], v[156:157], v[172:173] neg_lo:[0,1] neg_hi:[0,1]
    v_pk_add_f32 v[158:159], v[158:159], v[174:175] neg_lo:[0,1] neg_hi:[0,1]
    v_cvt_pk_bf16_f32 v184, v152, v153
    v_lshlrev_b32 v152, 16, v184
    v_and_b32 v153, 0xffff0000, v184
    v_cvt_pk_bf16_f32 v185, v154, v155
    v_lshlrev_b32 v154, 16, v185
    v_and_b32 v155, 0xffff0000, v185
    v_cvt_pk_bf16_f32 v186, v156, v157
    v_lshlrev_b32 v156, 16, v186
    v_and_b32 v157, 0xffff0000, v186
    v_cvt_pk_bf16_f32 v187, v158, v159
    v_lshlrev_b32 v158, 16, v187
    v_and_b32 v159, 0xffff0000, v187
    v_pk_mul_f32 v[152:153], v[152:153], v[176:177]
    v_pk_mul_f32 v[154:155], v[154:155], v[178:179]
    v_pk_mul_f32 v[156:157], v[156:157], v[180:181]
    v_pk_mul_f32 v[158:159], v[158:159], v[182:183]
    v_cvt_pk_bf16_f32 v60, v152, v153
    v_cvt_pk_bf16_f32 v61, v154, v155
    v_cvt_pk_bf16_f32 v62, v156, v157
    v_cvt_pk_bf16_f32 v63, v158, v159
    s_add_u32 s34, s35, 327680
    buffer_store_dwordx4 v[60:63], v7, s[20:23], s34 offen offset:128
    s_endpgm
k2_kv:
    s_waitcnt lgkmcnt(0)
    s_sub_u32 s24, s2, 208
    s_mov_b32 s20, s10
    s_and_b32 s21, s11, 0xffff
    s_mov_b32 s22, 25182208
    s_mov_b32 s23, 0x00020000
    v_and_b32 v1, 63, v0
    v_and_b32 v2, 15, v1
    v_lshrrev_b32 v3, 4, v1
    s_mul_i32 s33, s24, 20
    s_lshr_b32 s25, s33, 4
    s_and_b32 s26, s33, 15
    s_lshl_b32 s33, s25, 16
    s_lshl_b32 s34, s28, 13
    s_add_u32 s33, s33, s34
    v_lshlrev_b32 v4, 4, v1
    v_add_u32 v4, s33, v4
    v_add_u32 v5, 0x10000, v4
    s_mov_b32 s34, 2621440
    s_mov_b32 s35, 2625536
    s_movk_i32 s36, 4096
    buffer_load_dwordx4 v[16:19], v4, s[20:23], 0 offen offset:0
    buffer_load_dwordx4 v[20:23], v5, s[20:23], 0 offen offset:0
    buffer_load_dwordx4 v[24:27], v4, s[20:23], s34 offen offset:0
    buffer_load_dwordx4 v[28:31], v5, s[20:23], s34 offen offset:0
    buffer_load_dwordx4 v[32:35], v4, s[20:23], 0 offen offset:1024
    buffer_load_dwordx4 v[36:39], v5, s[20:23], 0 offen offset:1024
    buffer_load_dwordx4 v[40:43], v4, s[20:23], s34 offen offset:1024
    buffer_load_dwordx4 v[44:47], v5, s[20:23], s34 offen offset:1024
    buffer_load_dwordx4 v[48:51], v4, s[20:23], 0 offen offset:2048
    buffer_load_dwordx4 v[52:55], v5, s[20:23], 0 offen offset:2048
    buffer_load_dwordx4 v[56:59], v4, s[20:23], s34 offen offset:2048
    buffer_load_dwordx4 v[60:63], v5, s[20:23], s34 offen offset:2048
    buffer_load_dwordx4 v[64:67], v4, s[20:23], 0 offen offset:3072
    buffer_load_dwordx4 v[68:71], v5, s[20:23], 0 offen offset:3072
    buffer_load_dwordx4 v[72:75], v4, s[20:23], s34 offen offset:3072
    buffer_load_dwordx4 v[76:79], v5, s[20:23], s34 offen offset:3072
    buffer_load_dwordx4 v[80:83], v4, s[20:23], s36 offen offset:0
    buffer_load_dwordx4 v[84:87], v5, s[20:23], s36 offen offset:0
    buffer_load_dwordx4 v[88:91], v4, s[20:23], s35 offen offset:0
    buffer_load_dwordx4 v[92:95], v5, s[20:23], s35 offen offset:0
    buffer_load_dwordx4 v[96:99], v4, s[20:23], s36 offen offset:1024
    buffer_load_dwordx4 v[100:103], v5, s[20:23], s36 offen offset:1024
    buffer_load_dwordx4 v[104:107], v4, s[20:23], s35 offen offset:1024
    buffer_load_dwordx4 v[108:111], v5, s[20:23], s35 offen offset:1024
    buffer_load_dwordx4 v[112:115], v4, s[20:23], s36 offen offset:2048
    buffer_load_dwordx4 v[116:119], v5, s[20:23], s36 offen offset:2048
    buffer_load_dwordx4 v[120:123], v4, s[20:23], s35 offen offset:2048
    buffer_load_dwordx4 v[124:127], v5, s[20:23], s35 offen offset:2048
    buffer_load_dwordx4 v[128:131], v4, s[20:23], s36 offen offset:3072
    buffer_load_dwordx4 v[132:135], v5, s[20:23], s36 offen offset:3072
    buffer_load_dwordx4 v[136:139], v4, s[20:23], s35 offen offset:3072
    buffer_load_dwordx4 v[140:143], v5, s[20:23], s35 offen offset:3072
    v_mov_b32 v144, 0
    v_mov_b32 v145, 0
    v_mov_b32 v146, 0
    v_mov_b32 v147, 0
    v_mov_b32 v148, 0
    v_mov_b32 v149, 0
    v_mov_b32 v150, 0
    v_mov_b32 v151, 0
    v_mov_b32 v152, 0
    v_mov_b32 v153, 0
    v_mov_b32 v154, 0
    v_mov_b32 v155, 0
    v_mov_b32 v156, 0
    v_mov_b32 v157, 0
    v_mov_b32 v158, 0
    v_mov_b32 v159, 0
    v_mov_b32 v160, 0
    v_mov_b32 v161, 0
    v_mov_b32 v162, 0
    v_mov_b32 v163, 0
    v_mov_b32 v164, 0
    v_mov_b32 v165, 0
    v_mov_b32 v166, 0
    v_mov_b32 v167, 0
    v_mov_b32 v168, 0x3f803f80
    v_mov_b32 v169, 0x3f803f80
    v_mov_b32 v170, 0x3f803f80
    v_mov_b32 v171, 0x3f803f80
    s_waitcnt vmcnt(28)
    v_mfma_f32_16x16x32_bf16 v[144:147], v[16:19], v[24:27], v[144:147]
    v_mfma_f32_16x16x32_bf16 v[148:151], v[16:19], v[28:31], v[148:151]
    v_mfma_f32_16x16x32_bf16 v[160:163], v[16:19], v[168:171], v[160:163]
    v_mfma_f32_16x16x32_bf16 v[152:155], v[20:23], v[24:27], v[152:155]
    v_mfma_f32_16x16x32_bf16 v[156:159], v[20:23], v[28:31], v[156:159]
    v_mfma_f32_16x16x32_bf16 v[164:167], v[20:23], v[168:171], v[164:167]
    s_waitcnt vmcnt(24)
    v_mfma_f32_16x16x32_bf16 v[144:147], v[32:35], v[40:43], v[144:147]
    v_mfma_f32_16x16x32_bf16 v[148:151], v[32:35], v[44:47], v[148:151]
    v_mfma_f32_16x16x32_bf16 v[160:163], v[32:35], v[168:171], v[160:163]
    v_mfma_f32_16x16x32_bf16 v[152:155], v[36:39], v[40:43], v[152:155]
    v_mfma_f32_16x16x32_bf16 v[156:159], v[36:39], v[44:47], v[156:159]
    v_mfma_f32_16x16x32_bf16 v[164:167], v[36:39], v[168:171], v[164:167]
    s_waitcnt vmcnt(20)
    v_mfma_f32_16x16x32_bf16 v[144:147], v[48:51], v[56:59], v[144:147]
    v_mfma_f32_16x16x32_bf16 v[148:151], v[48:51], v[60:63], v[148:151]
    v_mfma_f32_16x16x32_bf16 v[160:163], v[48:51], v[168:171], v[160:163]
    v_mfma_f32_16x16x32_bf16 v[152:155], v[52:55], v[56:59], v[152:155]
    v_mfma_f32_16x16x32_bf16 v[156:159], v[52:55], v[60:63], v[156:159]
    v_mfma_f32_16x16x32_bf16 v[164:167], v[52:55], v[168:171], v[164:167]
    s_waitcnt vmcnt(16)
    v_mfma_f32_16x16x32_bf16 v[144:147], v[64:67], v[72:75], v[144:147]
    v_mfma_f32_16x16x32_bf16 v[148:151], v[64:67], v[76:79], v[148:151]
    v_mfma_f32_16x16x32_bf16 v[160:163], v[64:67], v[168:171], v[160:163]
    v_mfma_f32_16x16x32_bf16 v[152:155], v[68:71], v[72:75], v[152:155]
    v_mfma_f32_16x16x32_bf16 v[156:159], v[68:71], v[76:79], v[156:159]
    v_mfma_f32_16x16x32_bf16 v[164:167], v[68:71], v[168:171], v[164:167]
    s_waitcnt vmcnt(12)
    v_mfma_f32_16x16x32_bf16 v[144:147], v[80:83], v[88:91], v[144:147]
    v_mfma_f32_16x16x32_bf16 v[148:151], v[80:83], v[92:95], v[148:151]
    v_mfma_f32_16x16x32_bf16 v[160:163], v[80:83], v[168:171], v[160:163]
    v_mfma_f32_16x16x32_bf16 v[152:155], v[84:87], v[88:91], v[152:155]
    v_mfma_f32_16x16x32_bf16 v[156:159], v[84:87], v[92:95], v[156:159]
    v_mfma_f32_16x16x32_bf16 v[164:167], v[84:87], v[168:171], v[164:167]
    s_waitcnt vmcnt(8)
    v_mfma_f32_16x16x32_bf16 v[144:147], v[96:99], v[104:107], v[144:147]
    v_mfma_f32_16x16x32_bf16 v[148:151], v[96:99], v[108:111], v[148:151]
    v_mfma_f32_16x16x32_bf16 v[160:163], v[96:99], v[168:171], v[160:163]
    v_mfma_f32_16x16x32_bf16 v[152:155], v[100:103], v[104:107], v[152:155]
    v_mfma_f32_16x16x32_bf16 v[156:159], v[100:103], v[108:111], v[156:159]
    v_mfma_f32_16x16x32_bf16 v[164:167], v[100:103], v[168:171], v[164:167]
    s_waitcnt vmcnt(4)
    v_mfma_f32_16x16x32_bf16 v[144:147], v[112:115], v[120:123], v[144:147]
    v_mfma_f32_16x16x32_bf16 v[148:151], v[112:115], v[124:127], v[148:151]
    v_mfma_f32_16x16x32_bf16 v[160:163], v[112:115], v[168:171], v[160:163]
    v_mfma_f32_16x16x32_bf16 v[152:155], v[116:119], v[120:123], v[152:155]
    v_mfma_f32_16x16x32_bf16 v[156:159], v[116:119], v[124:127], v[156:159]
    v_mfma_f32_16x16x32_bf16 v[164:167], v[116:119], v[168:171], v[164:167]
    s_waitcnt vmcnt(0)
    v_mfma_f32_16x16x32_bf16 v[144:147], v[128:131], v[136:139], v[144:147]
    v_mfma_f32_16x16x32_bf16 v[148:151], v[128:131], v[140:143], v[148:151]
    v_mfma_f32_16x16x32_bf16 v[160:163], v[128:131], v[168:171], v[160:163]
    v_mfma_f32_16x16x32_bf16 v[152:155], v[132:135], v[136:139], v[152:155]
    v_mfma_f32_16x16x32_bf16 v[156:159], v[132:135], v[140:143], v[156:159]
    v_mfma_f32_16x16x32_bf16 v[164:167], v[132:135], v[168:171], v[164:167]
    s_lshl_b32 s33, s28, 12
    v_lshlrev_b32 v6, 7, v2
    v_lshl_add_u32 v6, v3, 4, v6
    v_add_u32 v6, s33, v6
    s_lshl_b32 s33, s28, 7
    v_lshlrev_b32 v7, 4, v3
    v_add_u32 v7, s33, v7
    ds_write_b128 v6, v[144:147] offset:0
    ds_write_b128 v6, v[148:151] offset:2048
    ds_write_b128 v7, v[160:163] offset:32768
    ds_write_b128 v6, v[152:155] offset:64
    ds_write_b128 v6, v[156:159] offset:2112
    ds_write_b128 v7, v[164:167] offset:32832
    s_waitcnt lgkmcnt(0)
    s_barrier
    v_lshrrev_b32 v8, 4, v0
    v_add_u32 v8, s26, v8
    v_min_u32 v8, 31, v8
    v_and_b32 v9, 15, v0
    v_lshlrev_b32 v10, 1, v9
    v_add_u32 v10, s26, v10
    v_min_u32 v10, 30, v10
    v_lshlrev_b32 v10, 2, v10
    v_lshl_add_u32 v8, v8, 7, v10
    ds_read_b64 v[16:17], v8 offset:0
    ds_read_b64 v[48:49], v10 offset:32768
    ds_read_b64 v[18:19], v8 offset:4096
    ds_read_b64 v[50:51], v10 offset:32896
    ds_read_b64 v[20:21], v8 offset:8192
    ds_read_b64 v[52:53], v10 offset:33024
    ds_read_b64 v[22:23], v8 offset:12288
    ds_read_b64 v[54:55], v10 offset:33152
    ds_read_b64 v[24:25], v8 offset:16384
    ds_read_b64 v[56:57], v10 offset:33280
    ds_read_b64 v[26:27], v8 offset:20480
    ds_read_b64 v[58:59], v10 offset:33408
    ds_read_b64 v[28:29], v8 offset:24576
    ds_read_b64 v[60:61], v10 offset:33536
    ds_read_b64 v[30:31], v8 offset:28672
    ds_read_b64 v[62:63], v10 offset:33664
    s_waitcnt lgkmcnt(0)
    v_add_f32 v16, v16, v18
    v_add_f32 v17, v17, v19
    v_add_f32 v16, v16, v20
    v_add_f32 v17, v17, v21
    v_add_f32 v16, v16, v22
    v_add_f32 v17, v17, v23
    v_add_f32 v16, v16, v24
    v_add_f32 v17, v17, v25
    v_add_f32 v16, v16, v26
    v_add_f32 v17, v17, v27
    v_add_f32 v16, v16, v28
    v_add_f32 v17, v17, v29
    v_add_f32 v16, v16, v30
    v_add_f32 v17, v17, v31
    v_add_f32 v48, v48, v50
    v_add_f32 v49, v49, v51
    v_add_f32 v48, v48, v52
    v_add_f32 v49, v49, v53
    v_add_f32 v48, v48, v54
    v_add_f32 v49, v49, v55
    v_add_f32 v48, v48, v56
    v_add_f32 v49, v49, v57
    v_add_f32 v48, v48, v58
    v_add_f32 v49, v49, v59
    v_add_f32 v48, v48, v60
    v_add_f32 v49, v49, v61
    v_add_f32 v48, v48, v62
    v_add_f32 v49, v49, v63
    v_cvt_pk_bf16_f32 v172, v16, v17
    v_cvt_pk_bf16_f32 v173, v48, v49
    v_cmp_gt_u32 vcc, 10, v9
    s_nop 1
    v_cndmask_b32 v172, 0, v172, vcc
    v_cndmask_b32 v173, 0, v173, vcc
    v_lshlrev_b32 v11, 2, v0
    s_lshl_b32 s33, s24, 11
    s_add_u32 s33, s33, 17301504
    buffer_store_dword v172, v11, s[20:23], s33 offen
    v_cmp_gt_u32 vcc, 16, v0
    v_mov_b32 v12, 0x7ffffff0
    s_nop 0
    v_cndmask_b32 v11, v12, v11, vcc
    s_lshl_b32 s33, s24, 6
    s_add_u32 s33, s33, 17367040
    buffer_store_dword v173, v11, s[20:23], s33 offen
    s_endpgm
k2_wt:
    s_waitcnt lgkmcnt(0)
    s_load_dwordx2 s[4:5], s[0:1], 16
    s_load_dwordx2 s[6:7], s[0:1], 56
    s_sub_u32 s24, s2, 240
    s_movk_i32 s26, 1280
    s_mov_b32 s27, 0
    v_and_b32 v1, 63, v0
    v_and_b32 v2, 31, v1
    v_lshrrev_b32 v3, 5, v1
    s_and_b32 s30, s28, 3
    s_lshr_b32 s29, s28, 2
    s_waitcnt lgkmcnt(0)
    s_mov_b32 s20, s10
    s_and_b32 s21, s11, 0xffff
    s_mov_b32 s22, 25182208
    s_mov_b32 s23, 0x00020000
    v_lshrrev_b32 v6, 4, v1
    s_lshl_b32 s33, s28, 3
    v_add_u32 v5, s33, v6
    v_mul_lo_u32 v5, v5, s26
    v_and_b32 v7, 15, v1
    v_lshrrev_b32 v7, 2, v7
    v_xor_b32 v7, v7, v6
    v_lshlrev_b32 v7, 2, v7
    v_and_b32 v8, 3, v1
    v_add_u32 v7, v7, v8
    v_lshlrev_b32 v7, 4, v7
    v_add_u32 v5, v5, v7
    v_add_u32 v178, s27, v5
    s_lshl_b32 s33, s26, 2
    s_sub_u32 s33, s33, 1024
    v_add_u32 v179, s33, v178
    v_and_b32 v5, 15, v1
    v_lshrrev_b32 v5, 2, v5
    v_and_b32 v6, 3, v1
    v_lshlrev_b32 v7, 3, v3
    v_add_u32 v7, v7, v5
    v_lshlrev_b32 v7, 8, v7
    v_xor_b32 v8, s30, v5
    v_lshlrev_b32 v8, 6, v8
    v_add_u32 v7, v7, v8
    v_lshrrev_b32 v8, 4, v1
    v_and_b32 v8, 1, v8
    v_lshlrev_b32 v8, 5, v8
    v_add_u32 v7, v7, v8
    v_lshlrev_b32 v6, 3, v6
    v_add_u32 v7, v7, v6
    s_lshl_b32 s33, s29, 13
    v_add_u32 v7, s33, v7
    s_lshl_b32 s35, s28, 11
    s_lshl_b32 s33, s30, 1
    v_lshrrev_b32 v9, 4, v1
    v_and_b32 v9, 1, v9
    v_add_u32 v9, s33, v9
    s_mov_b32 s33, 45056
    v_mul_lo_u32 v9, v9, s33
    v_lshlrev_b32 v10, 8, v3
    v_add_u32 v9, v9, v10
    v_and_b32 v10, 15, v1
    v_lshlrev_b32 v10, 4, v10
    v_add_u32 v9, v9, v10
    s_lshl_b32 s33, s29, 10
    v_add_u32 v9, s33, v9
    s_mov_b32 s18, 983040
    s_mov_b32 s19, 0x00020000
    s_add_u32 s40, s24, 0
    s_mul_i32 s41, s40, 52429
    s_lshr_b32 s41, s41, 18
    s_mul_i32 s42, s41, 5
    s_sub_u32 s42, s40, s42
    s_cmp_lt_u32 s41, 10
    s_cselect_b32 s16, s4, s6
    s_cselect_b32 s17, s5, s7
    s_cselect_b32 s43, 0, 10
    s_and_b32 s17, s17, 0xffff
    s_sub_u32 s43, s41, s43
    s_mul_i32 s43, s43, 81920
    s_lshl_b32 s44, s42, 8
    s_add_u32 s43, s43, s44
    s_add_u32 m0, s35, 0
    s_nop 0
    buffer_load_dwordx4 v178, s[16:19], s43 offen lds
    buffer_load_dwordx4 v179, s[16:19], s43 offen offset:1024 lds
    s_add_u32 s40, s24, 16
    s_mul_i32 s41, s40, 52429
    s_lshr_b32 s41, s41, 18
    s_mul_i32 s42, s41, 5
    s_sub_u32 s42, s40, s42
    s_cmp_lt_u32 s41, 10
    s_cselect_b32 s16, s4, s6
    s_cselect_b32 s17, s5, s7
    s_cselect_b32 s43, 0, 10
    s_and_b32 s17, s17, 0xffff
    s_sub_u32 s43, s41, s43
    s_mul_i32 s43, s43, 81920
    s_lshl_b32 s44, s42, 8
    s_add_u32 s43, s43, s44
    s_add_u32 m0, s35, 16384
    s_nop 0
    buffer_load_dwordx4 v178, s[16:19], s43 offen lds
    buffer_load_dwordx4 v179, s[16:19], s43 offen offset:1024 lds
    s_add_u32 s40, s24, 32
    s_mul_i32 s41, s40, 52429
    s_lshr_b32 s41, s41, 18
    s_mul_i32 s42, s41, 5
    s_sub_u32 s42, s40, s42
    s_cmp_lt_u32 s41, 10
    s_cselect_b32 s16, s4, s6
    s_cselect_b32 s17, s5, s7
    s_cselect_b32 s43, 0, 10
    s_and_b32 s17, s17, 0xffff
    s_sub_u32 s43, s41, s43
    s_mul_i32 s43, s43, 81920
    s_lshl_b32 s44, s42, 8
    s_add_u32 s43, s43, s44
    s_add_u32 m0, s35, 32768
    s_nop 0
    buffer_load_dwordx4 v178, s[16:19], s43 offen lds
    buffer_load_dwordx4 v179, s[16:19], s43 offen offset:1024 lds
    s_add_u32 s40, s24, 48
    s_mul_i32 s41, s40, 52429
    s_lshr_b32 s41, s41, 18
    s_mul_i32 s42, s41, 5
    s_sub_u32 s42, s40, s42
    s_cmp_lt_u32 s41, 10
    s_cselect_b32 s16, s4, s6
    s_cselect_b32 s17, s5, s7
    s_cselect_b32 s43, 0, 10
    s_and_b32 s17, s17, 0xffff
    s_sub_u32 s43, s41, s43
    s_mul_i32 s43, s43, 81920
    s_lshl_b32 s44, s42, 8
    s_add_u32 s43, s43, s44
    s_add_u32 m0, s35, 49152
    s_nop 0
    buffer_load_dwordx4 v178, s[16:19], s43 offen lds
    buffer_load_dwordx4 v179, s[16:19], s43 offen offset:1024 lds
    s_add_u32 s40, s24, 64
    s_mul_i32 s41, s40, 52429
    s_lshr_b32 s41, s41, 18
    s_mul_i32 s42, s41, 5
    s_sub_u32 s42, s40, s42
    s_cmp_lt_u32 s41, 10
    s_cselect_b32 s16, s4, s6
    s_cselect_b32 s17, s5, s7
    s_cselect_b32 s43, 0, 10
    s_and_b32 s17, s17, 0xffff
    s_sub_u32 s43, s41, s43
    s_mul_i32 s43, s43, 81920
    s_lshl_b32 s44, s42, 8
    s_add_u32 s43, s43, s44
    s_add_u32 m0, s35, 65536
    s_nop 0
    buffer_load_dwordx4 v178, s[16:19], s43 offen lds
    buffer_load_dwordx4 v179, s[16:19], s43 offen offset:1024 lds
    s_add_u32 s40, s24, 80
    s_mul_i32 s41, s40, 52429
    s_lshr_b32 s41, s41, 18
    s_mul_i32 s42, s41, 5
    s_sub_u32 s42, s40, s42
    s_cmp_lt_u32 s41, 10
    s_cselect_b32 s16, s4, s6
    s_cselect_b32 s17, s5, s7
    s_cselect_b32 s43, 0, 10
    s_and_b32 s17, s17, 0xffff
    s_sub_u32 s43, s41, s43
    s_mul_i32 s43, s43, 81920
    s_lshl_b32 s44, s42, 8
    s_add_u32 s43, s43, s44
    s_add_u32 m0, s35, 81920
    s_nop 0
    buffer_load_dwordx4 v178, s[16:19], s43 offen lds
    buffer_load_dwordx4 v179, s[16:19], s43 offen offset:1024 lds
    s_cmp_ge_u32 s24, 14
    s_cbranch_scc1 k2_wt_issued
    s_add_u32 s40, s24, 96
    s_mul_i32 s41, s40, 52429
    s_lshr_b32 s41, s41, 18
    s_mul_i32 s42, s41, 5
    s_sub_u32 s42, s40, s42
    s_cmp_lt_u32 s41, 10
    s_cselect_b32 s16, s4, s6
    s_cselect_b32 s17, s5, s7
    s_cselect_b32 s43, 0, 10
    s_and_b32 s17, s17, 0xffff
    s_sub_u32 s43, s41, s43
    s_mul_i32 s43, s43, 81920
    s_lshl_b32 s44, s42, 8
    s_add_u32 s43, s43, s44
    s_add_u32 m0, s35, 98304
    s_nop 0
    buffer_load_dwordx4 v178, s[16:19], s43 offen lds
    buffer_load_dwordx4 v179, s[16:19], s43 offen offset:1024 lds
k2_wt_issued:
    s_waitcnt vmcnt(0)
    s_barrier
    s_add_u32 s40, s24, 0
    s_mul_i32 s41, s40, 52429
    s_lshr_b32 s41, s41, 18
    s_mul_i32 s42, s41, 5
    s_sub_u32 s42, s40, s42
    v_add_u32 v11, 0, v7
    ds_read_b64_tr_b16 v[16:17], v11 offset:0
    ds_read_b64_tr_b16 v[18:19], v11 offset:1024
    ds_read_b64_tr_b16 v[20:21], v11 offset:4096
    ds_read_b64_tr_b16 v[22:23], v11 offset:5120
    s_mul_i32 s43, s42, 360448
    s_lshl_b32 s44, s41, 11
    s_add_u32 s43, s43, s44
    s_add_u32 s43, s43, 17432576
    s_waitcnt lgkmcnt(0)
    buffer_store_dwordx4 v[16:19], v9, s[20:23], s43 offen
    buffer_store_dwordx4 v[20:23], v9, s[20:23], s43 offen offset:512
    s_add_u32 s40, s24, 16
    s_mul_i32 s41, s40, 52429
    s_lshr_b32 s41, s41, 18
    s_mul_i32 s42, s41, 5
    s_sub_u32 s42, s40, s42
    v_add_u32 v11, 16384, v7
    ds_read_b64_tr_b16 v[24:25], v11 offset:0
    ds_read_b64_tr_b16 v[26:27], v11 offset:1024
    ds_read_b64_tr_b16 v[28:29], v11 offset:4096
    ds_read_b64_tr_b16 v[30:31], v11 offset:5120
    s_mul_i32 s43, s42, 360448
    s_lshl_b32 s44, s41, 11
    s_add_u32 s43, s43, s44
    s_add_u32 s43, s43, 17432576
    s_waitcnt lgkmcnt(0)
    buffer_store_dwordx4 v[24:27], v9, s[20:23], s43 offen
    buffer_store_dwordx4 v[28:31], v9, s[20:23], s43 offen offset:512
    s_add_u32 s40, s24, 32
    s_mul_i32 s41, s40, 52429
    s_lshr_b32 s41, s41, 18
    s_mul_i32 s42, s41, 5
    s_sub_u32 s42, s40, s42
    v_add_u32 v11, 32768, v7
    ds_read_b64_tr_b16 v[32:33], v11 offset:0
    ds_read_b64_tr_b16 v[34:35], v11 offset:1024
    ds_read_b64_tr_b16 v[36:37], v11 offset:4096
    ds_read_b64_tr_b16 v[38:39], v11 offset:5120
    s_mul_i32 s43, s42, 360448
    s_lshl_b32 s44, s41, 11
    s_add_u32 s43, s43, s44
    s_add_u32 s43, s43, 17432576
    s_waitcnt lgkmcnt(0)
    buffer_store_dwordx4 v[32:35], v9, s[20:23], s43 offen
    buffer_store_dwordx4 v[36:39], v9, s[20:23], s43 offen offset:512
    s_add_u32 s40, s24, 48
    s_mul_i32 s41, s40, 52429
    s_lshr_b32 s41, s41, 18
    s_mul_i32 s42, s41, 5
    s_sub_u32 s42, s40, s42
    v_add_u32 v11, 49152, v7
    ds_read_b64_tr_b16 v[40:41], v11 offset:0
    ds_read_b64_tr_b16 v[42:43], v11 offset:1024
    ds_read_b64_tr_b16 v[44:45], v11 offset:4096
    ds_read_b64_tr_b16 v[46:47], v11 offset:5120
    s_mul_i32 s43, s42, 360448
    s_lshl_b32 s44, s41, 11
    s_add_u32 s43, s43, s44
    s_add_u32 s43, s43, 17432576
    s_waitcnt lgkmcnt(0)
    buffer_store_dwordx4 v[40:43], v9, s[20:23], s43 offen
    buffer_store_dwordx4 v[44:47], v9, s[20:23], s43 offen offset:512
    s_add_u32 s40, s24, 64
    s_mul_i32 s41, s40, 52429
    s_lshr_b32 s41, s41, 18
    s_mul_i32 s42, s41, 5
    s_sub_u32 s42, s40, s42
    v_add_u32 v11, 65536, v7
    ds_read_b64_tr_b16 v[48:49], v11 offset:0
    ds_read_b64_tr_b16 v[50:51], v11 offset:1024
    ds_read_b64_tr_b16 v[52:53], v11 offset:4096
    ds_read_b64_tr_b16 v[54:55], v11 offset:5120
    s_mul_i32 s43, s42, 360448
    s_lshl_b32 s44, s41, 11
    s_add_u32 s43, s43, s44
    s_add_u32 s43, s43, 17432576
    s_waitcnt lgkmcnt(0)
    buffer_store_dwordx4 v[48:51], v9, s[20:23], s43 offen
    buffer_store_dwordx4 v[52:55], v9, s[20:23], s43 offen offset:512
    s_add_u32 s40, s24, 80
    s_mul_i32 s41, s40, 52429
    s_lshr_b32 s41, s41, 18
    s_mul_i32 s42, s41, 5
    s_sub_u32 s42, s40, s42
    v_add_u32 v11, 81920, v7
    ds_read_b64_tr_b16 v[56:57], v11 offset:0
    ds_read_b64_tr_b16 v[58:59], v11 offset:1024
    ds_read_b64_tr_b16 v[60:61], v11 offset:4096
    ds_read_b64_tr_b16 v[62:63], v11 offset:5120
    s_mul_i32 s43, s42, 360448
    s_lshl_b32 s44, s41, 11
    s_add_u32 s43, s43, s44
    s_add_u32 s43, s43, 17432576
    s_waitcnt lgkmcnt(0)
    buffer_store_dwordx4 v[56:59], v9, s[20:23], s43 offen
    buffer_store_dwordx4 v[60:63], v9, s[20:23], s43 offen offset:512
    s_cmp_ge_u32 s24, 14
    s_cbranch_scc1 k2_wt_done
    s_add_u32 s40, s24, 96
    s_mul_i32 s41, s40, 52429
    s_lshr_b32 s41, s41, 18
    s_mul_i32 s42, s41, 5
    s_sub_u32 s42, s40, s42
    v_add_u32 v11, 98304, v7
    ds_read_b64_tr_b16 v[64:65], v11 offset:0
    ds_read_b64_tr_b16 v[66:67], v11 offset:1024
    ds_read_b64_tr_b16 v[68:69], v11 offset:4096
    ds_read_b64_tr_b16 v[70:71], v11 offset:5120
    s_mul_i32 s43, s42, 360448
    s_lshl_b32 s44, s41, 11
    s_add_u32 s43, s43, s44
    s_add_u32 s43, s43, 17432576
    s_waitcnt lgkmcnt(0)
    buffer_store_dwordx4 v[64:67], v9, s[20:23], s43 offen
    buffer_store_dwordx4 v[68:71], v9, s[20:23], s43 offen offset:512
k2_wt_done:
    s_endpgm
k2_done:
    s_endpgm
.globl k3_kernel
.p2align 8
.type k3_kernel,@function
k3_kernel:
    s_cmp_ge_u32 s2, 256
    s_cbranch_scc1 k3_done
    s_load_dwordx4 s[4:7], s[0:1], 40
    s_load_dwordx2 s[10:11], s[0:1], 80
    v_lshrrev_b32 v2, 6, v0
    v_and_b32 v1, 63, v0
    v_readfirstlane_b32 s28, v2
    v_and_b32 v2, 15, v1
    v_lshrrev_b32 v3, 4, v1
    s_and_b32 s33, s2, 7
    s_lshr_b32 s26, s2, 3
    s_lshr_b32 s24, s33, 1
    s_lshl_b32 s24, s24, 3
    s_lshr_b32 s25, s26, 2
    s_add_u32 s24, s24, s25
    s_and_b32 s25, s33, 1
    s_lshl_b32 s25, s25, 2
    s_and_b32 s34, s26, 3
    s_add_u32 s25, s25, s34
    s_and_b32 s29, s28, 3
    s_lshr_b32 s30, s28, 2
    s_lshl_b32 s40, s24, 6
    s_mul_i32 s33, s28, 8
    s_add_u32 s33, s33, 0
    v_add_u32 v4, s33, v3
    v_and_b32 v5, 15, v4
    v_xor_b32 v5, v5, v2
    v_lshlrev_b32 v5, 4, v5
    v_add_u32 v4, s40, v4
    s_movk_i32 s34, 4096
    v_mul_lo_u32 v4, v4, s34
    v_add_u32 v4, v4, v5
    v_add_u32 v120, 0, v4
    s_mul_i32 s33, s28, 8
    s_add_u32 s33, s33, 4
    v_add_u32 v4, s33, v3
    v_and_b32 v5, 15, v4
    v_xor_b32 v5, v5, v2
    v_lshlrev_b32 v5, 4, v5
    v_add_u32 v4, s40, v4
    s_movk_i32 s34, 4096
    v_mul_lo_u32 v4, v4, s34
    v_add_u32 v4, v4, v5
    v_add_u32 v121, -1024, v4
    s_mul_i32 s33, s25, 6
    s_mul_i32 s34, s30, 3
    s_add_u32 s33, s33, s34
    s_lshl_b32 s33, s33, 16
    s_lshl_b32 s34, s29, 10
    s_add_u32 s33, s33, s34
    s_add_u32 s33, s33, 14155776
    v_lshlrev_b32 v4, 4, v1
    v_add_u32 v122, s33, v4
    v_add_u32 v123, 65536, v122
    v_add_u32 v124, 131072, v122
    s_lshl_b32 s42, s28, 11
    s_and_b32 s33, s2, 7
    s_lshl_b32 s49, s33, 1
    s_add_u32 s49, s49, s26
    s_waitcnt lgkmcnt(0)
    s_mov_b32 s12, s4
    s_and_b32 s13, s5, 0xffff
    s_mov_b32 s14, 8388608
    s_mov_b32 s15, 0x00020000
    s_mov_b32 s20, s10
    s_and_b32 s21, s11, 0xffff
    s_mov_b32 s22, 25182208
    s_mov_b32 s23, 0x00020000
    s_add_u32 s44, s49, 0
    s_and_b32 s44, s44, 15
    s_lshl_b32 s44, s44, 8
    s_add_u32 m0, s42, 0
    s_nop 0
    buffer_load_dwordx4 v120, s[12:15], s44 offen offset:0 lds
    buffer_load_dwordx4 v121, s[12:15], s44 offen offset:1024 lds
    s_add_u32 s45, s49, 0
    s_and_b32 s45, s45, 15
    s_lshl_b32 s45, s45, 12
    buffer_load_dwordx4 v[48:51], v122, s[20:23], s45 offen
    buffer_load_dwordx4 v[52:55], v123, s[20:23], s45 offen
    buffer_load_dwordx4 v[56:59], v124, s[20:23], s45 offen
    s_add_u32 s44, s49, 1
    s_and_b32 s44, s44, 15
    s_lshl_b32 s44, s44, 8
    s_add_u32 m0, s42, 16384
    s_nop 0
    buffer_load_dwordx4 v120, s[12:15], s44 offen offset:0 lds
    buffer_load_dwordx4 v121, s[12:15], s44 offen offset:1024 lds
    s_add_u32 s45, s49, 1
    s_and_b32 s45, s45, 15
    s_lshl_b32 s45, s45, 12
    buffer_load_dwordx4 v[60:63], v122, s[20:23], s45 offen
    buffer_load_dwordx4 v[64:67], v123, s[20:23], s45 offen
    buffer_load_dwordx4 v[68:71], v124, s[20:23], s45 offen
    s_mov_b32 s16, s6
    s_and_b32 s17, s7, 0xffff
    s_mov_b32 s18, 4096
    s_mov_b32 s19, 0x00020000
    s_lshl_b32 s33, s29, 2
    v_add_u32 v4, s33, v3
    v_xor_b32 v4, v4, v2
    v_lshlrev_b32 v4, 4, v4
    v_lshlrev_b32 v5, 8, v2
    v_add_u32 v125, v4, v5
    v_add_u32 v126, 49152, v125
    s_and_b32 s53, s2, 7
    s_lshr_b32 s53, s53, 1
    s_lshl_b32 s53, s53, 5
    s_add_u32 s53, s53, s26
    s_lshl_b32 s33, s53, 4
    v_add_u32 v4, s33, v2
    s_movk_i32 s34, 1280
    v_mul_lo_u32 v5, v4, s34
    v_lshlrev_b32 v6, 4, v3
    v_add_u32 v5, v5, v6
    s_and_b32 s35, s2, 1
    s_lshl_b32 s35, s35, 4
    s_lshl_b32 s34, s28, 1
    s_add_u32 s35, s35, s34
    s_mul_i32 s36, s35, 40
    s_add_u32 s37, s36, 8388608
    v_lshlrev_b32 v7, 6, v2
    v_add_u32 v7, v7, v6
    s_lshl_b32 s38, s35, 11
    s_add_u32 s38, s38, 17301504
    s_lshl_b32 s39, s35, 6
    s_add_u32 s39, s39, 17367040
    s_mul_i32 s36, s53, 45056
    s_add_u32 s36, s36, 19398656
    s_mul_i32 s33, s35, 20
    v_lshlrev_b32 v8, 2, v3
    v_add_u32 v8, s33, v8
    v_lshlrev_b32 v9, 4, v2
    v_cmp_eq_u32 s[50:51], 0, v3
    v_mov_b32 v127, 0x7ffffff0
    s_lshl_b32 s34, s29, 4
    s_add_u32 s33, s40, s34
    v_add_u32 v13, s33, v2
    s_movk_i32 s34, 1536
    v_mul_lo_u32 v14, v13, s34
    v_lshlrev_b32 v11, 3, v3
    v_add_u32 v14, v14, v11
    s_mul_i32 s52, s25, 192
    s_mul_i32 s33, s30, 96
    s_add_u32 s52, s52, s33
    s_add_u32 s47, s52, 11010048
    v_lshlrev_b32 v13, 1, v13
    v_lshrrev_b32 v10, 1, v3
    v_lshlrev_b32 v10, 8, v10
    v_and_b32 v11, 1, v3
    v_lshl_add_u32 v10, v11, 3, v10
    v_add_u32 v15, v10, v9
    s_lshl_b32 s33, s24, 2
    s_add_u32 s33, s33, s29
    s_mul_i32 s33, s33, 44
    s_mul_i32 s34, s25, 3
    s_add_u32 s33, s33, s34
    s_add_u32 s33, s33, 20
    s_lshl_b32 s48, s33, 10
    s_mul_i32 s33, s30, 1536
    s_add_u32 s48, s48, s33
    s_add_u32 s48, s48, 19398656
    s_waitcnt vmcnt(8)
    s_barrier
    ds_read_b128 a[48:51], v125 offset:0
    ds_read_b128 a[52:55], v125 offset:4096
    ds_read_b128 a[56:59], v125 offset:8192
    ds_read_b128 a[60:63], v125 offset:12288
    s_waitcnt lgkmcnt(0)
    s_waitcnt vmcnt(3)
    s_barrier
    v_mfma_f32_16x16x32_bf16 a[0:3], v[48:51], a[48:51], 0
    s_add_u32 s44, s49, 2
    s_and_b32 s44, s44, 15
    s_lshl_b32 s44, s44, 8
    s_add_u32 m0, s42, 32768
    s_nop 0
    buffer_load_dwordx4 v120, s[12:15], s44 offen offset:0 lds
    buffer_load_dwordx4 v121, s[12:15], s44 offen offset:1024 lds
    v_mfma_f32_16x16x32_bf16 a[16:19], v[52:55], a[48:51], 0
    ds_read_b128 a[64:67], v125 offset:16384
    v_mfma_f32_16x16x32_bf16 a[32:35], v[56:59], a[48:51], 0
    s_add_u32 s45, s49, 2
    s_and_b32 s45, s45, 15
    s_lshl_b32 s45, s45, 12
    buffer_load_dwordx4 v[72:75], v122, s[20:23], s45 offen
    buffer_load_dwordx4 v[76:79], v123, s[20:23], s45 offen
    buffer_load_dwordx4 v[80:83], v124, s[20:23], s45 offen
    v_mfma_f32_16x16x32_bf16 a[4:7], v[48:51], a[52:55], 0
    ds_read_b128 a[68:71], v125 offset:20480
    v_mfma_f32_16x16x32_bf16 a[20:23], v[52:55], a[52:55], 0
    v_mfma_f32_16x16x32_bf16 a[36:39], v[56:59], a[52:55], 0
    ds_read_b128 a[72:75], v125 offset:24576
    v_mfma_f32_16x16x32_bf16 a[8:11], v[48:51], a[56:59], 0
    s_add_u32 s44, s49, 3
    s_and_b32 s44, s44, 15
    s_lshl_b32 s44, s44, 8
    s_add_u32 m0, s42, 49152
    s_nop 0
    buffer_load_dwordx4 v120, s[12:15], s44 offen offset:0 lds
    buffer_load_dwordx4 v121, s[12:15], s44 offen offset:1024 lds
    v_mfma_f32_16x16x32_bf16 a[24:27], v[52:55], a[56:59], 0
    ds_read_b128 a[76:79], v125 offset:28672
    v_mfma_f32_16x16x32_bf16 a[40:43], v[56:59], a[56:59], 0
    s_add_u32 s45, s49, 3
    s_and_b32 s45, s45, 15
    s_lshl_b32 s45, s45, 12
    buffer_load_dwordx4 v[84:87], v122, s[20:23], s45 offen
    buffer_load_dwordx4 v[88:91], v123, s[20:23], s45 offen
    buffer_load_dwordx4 v[92:95], v124, s[20:23], s45 offen
    v_mfma_f32_16x16x32_bf16 a[12:15], v[48:51], a[60:63], 0
    v_mfma_f32_16x16x32_bf16 a[28:31], v[52:55], a[60:63], 0
    v_mfma_f32_16x16x32_bf16 a[44:47], v[56:59], a[60:63], 0
    s_waitcnt lgkmcnt(0)
    s_waitcnt vmcnt(8)
    s_barrier
    v_mfma_f32_16x16x32_bf16 a[0:3], v[60:63], a[64:67], a[0:3]
    s_add_u32 s44, s49, 4
    s_and_b32 s44, s44, 15
    s_lshl_b32 s44, s44, 8
    s_add_u32 m0, s42, 65536
    s_nop 0
    buffer_load_dwordx4 v120, s[12:15], s44 offen offset:0 lds
    buffer_load_dwordx4 v121, s[12:15], s44 offen offset:1024 lds
    v_mfma_f32_16x16x32_bf16 a[16:19], v[64:67], a[64:67], a[16:19]
    ds_read_b128 a[48:51], v125 offset:32768
    v_mfma_f32_16x16x32_bf16 a[32:35], v[68:71], a[64:67], a[32:35]
    s_add_u32 s45, s49, 4
    s_and_b32 s45, s45, 15
    s_lshl_b32 s45, s45, 12
    buffer_load_dwordx4 v[96:99], v122, s[20:23], s45 offen
    buffer_load_dwordx4 v[100:103], v123, s[20:23], s45 offen
    buffer_load_dwordx4 v[104:107], v124, s[20:23], s45 offen
    v_mfma_f32_16x16x32_bf16 a[4:7], v[60:63], a[68:71], a[4:7]
    ds_read_b128 a[52:55], v125 offset:36864
    v_mfma_f32_16x16x32_bf16 a[20:23], v[64:67], a[68:71], a[20:23]
    v_mfma_f32_16x16x32_bf16 a[36:39], v[68:71], a[68:71], a[36:39]
    ds_read_b128 a[56:59], v125 offset:40960
    v_mfma_f32_16x16x32_bf16 a[8:11], v[60:63], a[72:75], a[8:11]
    s_add_u32 s44, s49, 5
    s_and_b32 s44, s44, 15
    s_lshl_b32 s44, s44, 8
    s_add_u32 m0, s42, 81920
    s_nop 0
    buffer_load_dwordx4 v120, s[12:15], s44 offen offset:0 lds
    buffer_load_dwordx4 v121, s[12:15], s44 offen offset:1024 lds
    v_mfma_f32_16x16x32_bf16 a[24:27], v[64:67], a[72:75], a[24:27]
    ds_read_b128 a[60:63], v125 offset:45056
    v_mfma_f32_16x16x32_bf16 a[40:43], v[68:71], a[72:75], a[40:43]
    s_add_u32 s45, s49, 5
    s_and_b32 s45, s45, 15
    s_lshl_b32 s45, s45, 12
    buffer_load_dwordx4 v[108:111], v122, s[20:23], s45 offen
    buffer_load_dwordx4 v[112:115], v123, s[20:23], s45 offen
    buffer_load_dwordx4 v[116:119], v124, s[20:23], s45 offen
    v_mfma_f32_16x16x32_bf16 a[12:15], v[60:63], a[76:79], a[12:15]
    v_mfma_f32_16x16x32_bf16 a[28:31], v[64:67], a[76:79], a[28:31]
    v_mfma_f32_16x16x32_bf16 a[44:47], v[68:71], a[76:79], a[44:47]
    s_waitcnt lgkmcnt(0)
    s_waitcnt vmcnt(13)
    s_barrier
    v_mfma_f32_16x16x32_bf16 a[0:3], v[72:75], a[48:51], a[0:3]
    s_add_u32 s44, s49, 6
    s_and_b32 s44, s44, 15
    s_lshl_b32 s44, s44, 8
    s_add_u32 m0, s42, 0
    s_nop 0
    buffer_load_dwordx4 v120, s[12:15], s44 offen offset:0 lds
    buffer_load_dwordx4 v121, s[12:15], s44 offen offset:1024 lds
    v_mfma_f32_16x16x32_bf16 a[16:19], v[76:79], a[48:51], a[16:19]
    ds_read_b128 a[64:67], v126 offset:0
    v_mfma_f32_16x16x32_bf16 a[32:35], v[80:83], a[48:51], a[32:35]
    s_add_u32 s45, s49, 6
    s_and_b32 s45, s45, 15
    s_lshl_b32 s45, s45, 12
    buffer_load_dwordx4 v[48:51], v122, s[20:23], s45 offen
    buffer_load_dwordx4 v[52:55], v123, s[20:23], s45 offen
    buffer_load_dwordx4 v[56:59], v124, s[20:23], s45 offen
    v_mfma_f32_16x16x32_bf16 a[4:7], v[72:75], a[52:55], a[4:7]
    ds_read_b128 a[68:71], v126 offset:4096
    v_mfma_f32_16x16x32_bf16 a[20:23], v[76:79], a[52:55], a[20:23]
    v_mfma_f32_16x16x32_bf16 a[36:39], v[80:83], a[52:55], a[36:39]
    ds_read_b128 a[72:75], v126 offset:8192
    v_mfma_f32_16x16x32_bf16 a[8:11], v[72:75], a[56:59], a[8:11]
    s_add_u32 s44, s49, 7
    s_and_b32 s44, s44, 15
    s_lshl_b32 s44, s44, 8
    s_add_u32 m0, s42, 16384
    s_nop 0
    buffer_load_dwordx4 v120, s[12:15], s44 offen offset:0 lds
    buffer_load_dwordx4 v121, s[12:15], s44 offen offset:1024 lds
    v_mfma_f32_16x16x32_bf16 a[24:27], v[76:79], a[56:59], a[24:27]
    ds_read_b128 a[76:79], v126 offset:12288
    v_mfma_f32_16x16x32_bf16 a[40:43], v[80:83], a[56:59], a[40:43]
    s_add_u32 s45, s49, 7
    s_and_b32 s45, s45, 15
    s_lshl_b32 s45, s45, 12
    buffer_load_dwordx4 v[60:63], v122, s[20:23], s45 offen
    buffer_load_dwordx4 v[64:67], v123, s[20:23], s45 offen
    buffer_load_dwordx4 v[68:71], v124, s[20:23], s45 offen
    v_mfma_f32_16x16x32_bf16 a[12:15], v[72:75], a[60:63], a[12:15]
    v_mfma_f32_16x16x32_bf16 a[28:31], v[76:79], a[60:63], a[28:31]
    v_mfma_f32_16x16x32_bf16 a[44:47], v[80:83], a[60:63], a[44:47]
    s_waitcnt lgkmcnt(0)
    s_waitcnt vmcnt(18)
    s_barrier
    v_mfma_f32_16x16x32_bf16 a[0:3], v[84:87], a[64:67], a[0:3]
    s_add_u32 s44, s49, 8
    s_and_b32 s44, s44, 15
    s_lshl_b32 s44, s44, 8
    s_add_u32 m0, s42, 32768
    s_nop 0
    buffer_load_dwordx4 v120, s[12:15], s44 offen offset:0 lds
    buffer_load_dwordx4 v121, s[12:15], s44 offen offset:1024 lds
    v_mfma_f32_16x16x32_bf16 a[16:19], v[88:91], a[64:67], a[16:19]
    ds_read_b128 a[48:51], v126 offset:16384
    v_mfma_f32_16x16x32_bf16 a[32:35], v[92:95], a[64:67], a[32:35]
    s_add_u32 s45, s49, 8
    s_and_b32 s45, s45, 15
    s_lshl_b32 s45, s45, 12
    buffer_load_dwordx4 v[72:75], v122, s[20:23], s45 offen
    buffer_load_dwordx4 v[76:79], v123, s[20:23], s45 offen
    buffer_load_dwordx4 v[80:83], v124, s[20:23], s45 offen
    v_mfma_f32_16x16x32_bf16 a[4:7], v[84:87], a[68:71], a[4:7]
    ds_read_b128 a[52:55], v126 offset:20480
    v_mfma_f32_16x16x32_bf16 a[20:23], v[88:91], a[68:71], a[20:23]
    v_mfma_f32_16x16x32_bf16 a[36:39], v[92:95], a[68:71], a[36:39]
    ds_read_b128 a[56:59], v126 offset:24576
    v_mfma_f32_16x16x32_bf16 a[8:11], v[84:87], a[72:75], a[8:11]
    v_mfma_f32_16x16x32_bf16 a[24:27], v[88:91], a[72:75], a[24:27]
    ds_read_b128 a[60:63], v126 offset:28672
    v_mfma_f32_16x16x32_bf16 a[40:43], v[92:95], a[72:75], a[40:43]
    v_mfma_f32_16x16x32_bf16 a[12:15], v[84:87], a[76:79], a[12:15]
    v_mfma_f32_16x16x32_bf16 a[28:31], v[88:91], a[76:79], a[28:31]
    v_mfma_f32_16x16x32_bf16 a[44:47], v[92:95], a[76:79], a[44:47]
    s_waitcnt lgkmcnt(0)
    s_waitcnt vmcnt(18)
    s_barrier
    v_mfma_f32_16x16x32_bf16 a[0:3], v[96:99], a[48:51], a[0:3]
    s_add_u32 s44, s49, 9
    s_and_b32 s44, s44, 15
    s_lshl_b32 s44, s44, 8
    s_add_u32 m0, s42, 49152
    s_nop 0
    buffer_load_dwordx4 v120, s[12:15], s44 offen offset:0 lds
    buffer_load_dwordx4 v121, s[12:15], s44 offen offset:1024 lds
    v_mfma_f32_16x16x32_bf16 a[16:19], v[100:103], a[48:51], a[16:19]
    ds_read_b128 a[64:67], v126 offset:32768
    v_mfma_f32_16x16x32_bf16 a[32:35], v[104:107], a[48:51], a[32:35]
    s_add_u32 s45, s49, 9
    s_and_b32 s45, s45, 15
    s_lshl_b32 s45, s45, 12
    buffer_load_dwordx4 v[84:87], v122, s[20:23], s45 offen
    buffer_load_dwordx4 v[88:91], v123, s[20:23], s45 offen
    buffer_load_dwordx4 v[92:95], v124, s[20:23], s45 offen
    v_mfma_f32_16x16x32_bf16 a[4:7], v[96:99], a[52:55], a[4:7]
    ds_read_b128 a[68:71], v126 offset:36864
    v_mfma_f32_16x16x32_bf16 a[20:23], v[100:103], a[52:55], a[20:23]
    v_mfma_f32_16x16x32_bf16 a[36:39], v[104:107], a[52:55], a[36:39]
    ds_read_b128 a[72:75], v126 offset:40960
    v_mfma_f32_16x16x32_bf16 a[8:11], v[96:99], a[56:59], a[8:11]
    v_mfma_f32_16x16x32_bf16 a[24:27], v[100:103], a[56:59], a[24:27]
    ds_read_b128 a[76:79], v126 offset:45056
    v_mfma_f32_16x16x32_bf16 a[40:43], v[104:107], a[56:59], a[40:43]
    v_mfma_f32_16x16x32_bf16 a[12:15], v[96:99], a[60:63], a[12:15]
    v_mfma_f32_16x16x32_bf16 a[28:31], v[100:103], a[60:63], a[28:31]
    v_mfma_f32_16x16x32_bf16 a[44:47], v[104:107], a[60:63], a[44:47]
    s_waitcnt lgkmcnt(0)
    s_waitcnt vmcnt(18)
    s_barrier
    v_mfma_f32_16x16x32_bf16 a[0:3], v[108:111], a[64:67], a[0:3]
    s_add_u32 s44, s49, 10
    s_and_b32 s44, s44, 15
    s_lshl_b32 s44, s44, 8
    s_add_u32 m0, s42, 65536
    s_nop 0
    buffer_load_dwordx4 v120, s[12:15], s44 offen offset:0 lds
    buffer_load_dwordx4 v121, s[12:15], s44 offen offset:1024 lds
    v_mfma_f32_16x16x32_bf16 a[16:19], v[112:115], a[64:67], a[16:19]
    ds_read_b128 a[48:51], v125 offset:0
    v_mfma_f32_16x16x32_bf16 a[32:35], v[116:119], a[64:67], a[32:35]
    s_add_u32 s45, s49, 10
    s_and_b32 s45, s45, 15
    s_lshl_b32 s45, s45, 12
    buffer_load_dwordx4 v[96:99], v122, s[20:23], s45 offen
    buffer_load_dwordx4 v[100:103], v123, s[20:23], s45 offen
    buffer_load_dwordx4 v[104:107], v124, s[20:23], s45 offen
    v_mfma_f32_16x16x32_bf16 a[4:7], v[108:111], a[68:71], a[4:7]
    ds_read_b128 a[52:55], v125 offset:4096
    v_mfma_f32_16x16x32_bf16 a[20:23], v[112:115], a[68:71], a[20:23]
    v_mfma_f32_16x16x32_bf16 a[36:39], v[116:119], a[68:71], a[36:39]
    ds_read_b128 a[56:59], v125 offset:8192
    v_mfma_f32_16x16x32_bf16 a[8:11], v[108:111], a[72:75], a[8:11]
    v_mfma_f32_16x16x32_bf16 a[24:27], v[112:115], a[72:75], a[24:27]
    ds_read_b128 a[60:63], v125 offset:12288
    v_mfma_f32_16x16x32_bf16 a[40:43], v[116:119], a[72:75], a[40:43]
    v_mfma_f32_16x16x32_bf16 a[12:15], v[108:111], a[76:79], a[12:15]
    v_mfma_f32_16x16x32_bf16 a[28:31], v[112:115], a[76:79], a[28:31]
    v_mfma_f32_16x16x32_bf16 a[44:47], v[116:119], a[76:79], a[44:47]
    s_waitcnt lgkmcnt(0)
    s_waitcnt vmcnt(18)
    s_barrier
    v_mfma_f32_16x16x32_bf16 a[0:3], v[48:51], a[48:51], a[0:3]
    s_add_u32 s44, s49, 11
    s_and_b32 s44, s44, 15
    s_lshl_b32 s44, s44, 8
    s_add_u32 m0, s42, 81920
    s_nop 0
    buffer_load_dwordx4 v120, s[12:15], s44 offen offset:0 lds
    buffer_load_dwordx4 v121, s[12:15], s44 offen offset:1024 lds
    v_mfma_f32_16x16x32_bf16 a[16:19], v[52:55], a[48:51], a[16:19]
    ds_read_b128 a[64:67], v125 offset:16384
    v_mfma_f32_16x16x32_bf16 a[32:35], v[56:59], a[48:51], a[32:35]
    s_add_u32 s45, s49, 11
    s_and_b32 s45, s45, 15
    s_lshl_b32 s45, s45, 12
    buffer_load_dwordx4 v[108:111], v122, s[20:23], s45 offen
    buffer_load_dwordx4 v[112:115], v123, s[20:23], s45 offen
    buffer_load_dwordx4 v[116:119], v124, s[20:23], s45 offen
    v_mfma_f32_16x16x32_bf16 a[4:7], v[48:51], a[52:55], a[4:7]
    ds_read_b128 a[68:71], v125 offset:20480
    v_mfma_f32_16x16x32_bf16 a[20:23], v[52:55], a[52:55], a[20:23]
    v_mfma_f32_16x16x32_bf16 a[36:39], v[56:59], a[52:55], a[36:39]
    ds_read_b128 a[72:75], v125 offset:24576
    v_mfma_f32_16x16x32_bf16 a[8:11], v[48:51], a[56:59], a[8:11]
    v_mfma_f32_16x16x32_bf16 a[24:27], v[52:55], a[56:59], a[24:27]
    ds_read_b128 a[76:79], v125 offset:28672
    v_mfma_f32_16x16x32_bf16 a[40:43], v[56:59], a[56:59], a[40:43]
    v_mfma_f32_16x16x32_bf16 a[12:15], v[48:51], a[60:63], a[12:15]
    v_mfma_f32_16x16x32_bf16 a[28:31], v[52:55], a[60:63], a[28:31]
    v_mfma_f32_16x16x32_bf16 a[44:47], v[56:59], a[60:63], a[44:47]
    s_waitcnt lgkmcnt(0)
    s_waitcnt vmcnt(18)
    s_barrier
    v_mfma_f32_16x16x32_bf16 a[0:3], v[60:63], a[64:67], a[0:3]
    s_add_u32 s44, s49, 12
    s_and_b32 s44, s44, 15
    s_lshl_b32 s44, s44, 8
    s_add_u32 m0, s42, 0
    s_nop 0
    buffer_load_dwordx4 v120, s[12:15], s44 offen offset:0 lds
    buffer_load_dwordx4 v121, s[12:15], s44 offen offset:1024 lds
    v_mfma_f32_16x16x32_bf16 a[16:19], v[64:67], a[64:67], a[16:19]
    ds_read_b128 a[48:51], v125 offset:32768
    v_mfma_f32_16x16x32_bf16 a[32:35], v[68:71], a[64:67], a[32:35]
    s_add_u32 s45, s49, 12
    s_and_b32 s45, s45, 15
    s_lshl_b32 s45, s45, 12
    buffer_load_dwordx4 v[48:51], v122, s[20:23], s45 offen
    buffer_load_dwordx4 v[52:55], v123, s[20:23], s45 offen
    buffer_load_dwordx4 v[56:59], v124, s[20:23], s45 offen
    v_mfma_f32_16x16x32_bf16 a[4:7], v[60:63], a[68:71], a[4:7]
    ds_read_b128 a[52:55], v125 offset:36864
    v_mfma_f32_16x16x32_bf16 a[20:23], v[64:67], a[68:71], a[20:23]
    v_mfma_f32_16x16x32_bf16 a[36:39], v[68:71], a[68:71], a[36:39]
    ds_read_b128 a[56:59], v125 offset:40960
    v_mfma_f32_16x16x32_bf16 a[8:11], v[60:63], a[72:75], a[8:11]
    v_mfma_f32_16x16x32_bf16 a[24:27], v[64:67], a[72:75], a[24:27]
    ds_read_b128 a[60:63], v125 offset:45056
    v_mfma_f32_16x16x32_bf16 a[40:43], v[68:71], a[72:75], a[40:43]
    v_mfma_f32_16x16x32_bf16 a[12:15], v[60:63], a[76:79], a[12:15]
    v_mfma_f32_16x16x32_bf16 a[28:31], v[64:67], a[76:79], a[28:31]
    v_mfma_f32_16x16x32_bf16 a[44:47], v[68:71], a[76:79], a[44:47]
    s_waitcnt lgkmcnt(0)
    s_waitcnt vmcnt(18)
    s_barrier
    v_mfma_f32_16x16x32_bf16 a[0:3], v[72:75], a[48:51], a[0:3]
    s_add_u32 s44, s49, 13
    s_and_b32 s44, s44, 15
    s_lshl_b32 s44, s44, 8
    s_add_u32 m0, s42, 16384
    s_nop 0
    buffer_load_dwordx4 v120, s[12:15], s44 offen offset:0 lds
    buffer_load_dwordx4 v121, s[12:15], s44 offen offset:1024 lds
    v_mfma_f32_16x16x32_bf16 a[16:19], v[76:79], a[48:51], a[16:19]
    ds_read_b128 a[64:67], v126 offset:0
    v_mfma_f32_16x16x32_bf16 a[32:35], v[80:83], a[48:51], a[32:35]
    s_add_u32 s45, s49, 13
    s_and_b32 s45, s45, 15
    s_lshl_b32 s45, s45, 12
    buffer_load_dwordx4 v[60:63], v122, s[20:23], s45 offen
    buffer_load_dwordx4 v[64:67], v123, s[20:23], s45 offen
    buffer_load_dwordx4 v[68:71], v124, s[20:23], s45 offen
    v_mfma_f32_16x16x32_bf16 a[4:7], v[72:75], a[52:55], a[4:7]
    ds_read_b128 a[68:71], v126 offset:4096
    v_mfma_f32_16x16x32_bf16 a[20:23], v[76:79], a[52:55], a[20:23]
    v_mfma_f32_16x16x32_bf16 a[36:39], v[80:83], a[52:55], a[36:39]
    ds_read_b128 a[72:75], v126 offset:8192
    v_mfma_f32_16x16x32_bf16 a[8:11], v[72:75], a[56:59], a[8:11]
    v_mfma_f32_16x16x32_bf16 a[24:27], v[76:79], a[56:59], a[24:27]
    ds_read_b128 a[76:79], v126 offset:12288
    v_mfma_f32_16x16x32_bf16 a[40:43], v[80:83], a[56:59], a[40:43]
    v_mfma_f32_16x16x32_bf16 a[12:15], v[72:75], a[60:63], a[12:15]
    v_mfma_f32_16x16x32_bf16 a[28:31], v[76:79], a[60:63], a[28:31]
    v_mfma_f32_16x16x32_bf16 a[44:47], v[80:83], a[60:63], a[44:47]
    s_waitcnt lgkmcnt(0)
    s_waitcnt vmcnt(18)
    s_barrier
    v_mfma_f32_16x16x32_bf16 a[0:3], v[84:87], a[64:67], a[0:3]
    s_add_u32 s44, s49, 14
    s_and_b32 s44, s44, 15
    s_lshl_b32 s44, s44, 8
    s_add_u32 m0, s42, 32768
    s_nop 0
    buffer_load_dwordx4 v120, s[12:15], s44 offen offset:0 lds
    buffer_load_dwordx4 v121, s[12:15], s44 offen offset:1024 lds
    v_mfma_f32_16x16x32_bf16 a[16:19], v[88:91], a[64:67], a[16:19]
    ds_read_b128 a[48:51], v126 offset:16384
    v_mfma_f32_16x16x32_bf16 a[32:35], v[92:95], a[64:67], a[32:35]
    s_add_u32 s45, s49, 14
    s_and_b32 s45, s45, 15
    s_lshl_b32 s45, s45, 12
    buffer_load_dwordx4 v[72:75], v122, s[20:23], s45 offen
    buffer_load_dwordx4 v[76:79], v123, s[20:23], s45 offen
    buffer_load_dwordx4 v[80:83], v124, s[20:23], s45 offen
    v_mfma_f32_16x16x32_bf16 a[4:7], v[84:87], a[68:71], a[4:7]
    ds_read_b128 a[52:55], v126 offset:20480
    v_mfma_f32_16x16x32_bf16 a[20:23], v[88:91], a[68:71], a[20:23]
    v_mfma_f32_16x16x32_bf16 a[36:39], v[92:95], a[68:71], a[36:39]
    ds_read_b128 a[56:59], v126 offset:24576
    v_mfma_f32_16x16x32_bf16 a[8:11], v[84:87], a[72:75], a[8:11]
    v_mfma_f32_16x16x32_bf16 a[24:27], v[88:91], a[72:75], a[24:27]
    ds_read_b128 a[60:63], v126 offset:28672
    v_mfma_f32_16x16x32_bf16 a[40:43], v[92:95], a[72:75], a[40:43]
    v_mfma_f32_16x16x32_bf16 a[12:15], v[84:87], a[76:79], a[12:15]
    v_mfma_f32_16x16x32_bf16 a[28:31], v[88:91], a[76:79], a[28:31]
    v_mfma_f32_16x16x32_bf16 a[44:47], v[92:95], a[76:79], a[44:47]
    s_waitcnt lgkmcnt(0)
    s_waitcnt vmcnt(18)
    s_barrier
    v_mfma_f32_16x16x32_bf16 a[0:3], v[96:99], a[48:51], a[0:3]
    s_add_u32 s44, s49, 15
    s_and_b32 s44, s44, 15
    s_lshl_b32 s44, s44, 8
    s_add_u32 m0, s42, 49152
    s_nop 0
    buffer_load_dwordx4 v120, s[12:15], s44 offen offset:0 lds
    buffer_load_dwordx4 v121, s[12:15], s44 offen offset:1024 lds
    v_mfma_f32_16x16x32_bf16 a[16:19], v[100:103], a[48:51], a[16:19]
    ds_read_b128 a[64:67], v126 offset:32768
    v_mfma_f32_16x16x32_bf16 a[32:35], v[104:107], a[48:51], a[32:35]
    s_add_u32 s45, s49, 15
    s_and_b32 s45, s45, 15
    s_lshl_b32 s45, s45, 12
    buffer_load_dwordx4 v[84:87], v122, s[20:23], s45 offen
    buffer_load_dwordx4 v[88:91], v123, s[20:23], s45 offen
    buffer_load_dwordx4 v[92:95], v124, s[20:23], s45 offen
    v_mfma_f32_16x16x32_bf16 a[4:7], v[96:99], a[52:55], a[4:7]
    ds_read_b128 a[68:71], v126 offset:36864
    v_mfma_f32_16x16x32_bf16 a[20:23], v[100:103], a[52:55], a[20:23]
    v_mfma_f32_16x16x32_bf16 a[36:39], v[104:107], a[52:55], a[36:39]
    ds_read_b128 a[72:75], v126 offset:40960
    v_mfma_f32_16x16x32_bf16 a[8:11], v[96:99], a[56:59], a[8:11]
    v_mfma_f32_16x16x32_bf16 a[24:27], v[100:103], a[56:59], a[24:27]
    ds_read_b128 a[76:79], v126 offset:45056
    v_mfma_f32_16x16x32_bf16 a[40:43], v[104:107], a[56:59], a[40:43]
    v_mfma_f32_16x16x32_bf16 a[12:15], v[96:99], a[60:63], a[12:15]
    v_mfma_f32_16x16x32_bf16 a[28:31], v[100:103], a[60:63], a[28:31]
    v_mfma_f32_16x16x32_bf16 a[44:47], v[104:107], a[60:63], a[44:47]
    buffer_load_dwordx4 v[16:19], v5, s[20:23], s37 offen offset:0
    buffer_load_dwordx4 v[20:23], v7, s[20:23], s38 offen offset:0
    buffer_load_dwordx4 v[24:27], v7, s[20:23], s38 offen offset:1024
    buffer_load_dwordx4 v[28:31], v6, s[20:23], s39 offen offset:0
    buffer_load_dwordx4 v[32:35], v5, s[20:23], s37 offen offset:40
    buffer_load_dwordx4 v[36:39], v7, s[20:23], s38 offen offset:2048
    buffer_load_dwordx4 v[40:43], v7, s[20:23], s38 offen offset:3072
    buffer_load_dwordx4 v[44:47], v6, s[20:23], s39 offen offset:64
    s_waitcnt lgkmcnt(0)
    s_waitcnt vmcnt(26)
    s_barrier
    v_mfma_f32_16x16x32_bf16 a[0:3], v[108:111], a[64:67], a[0:3]
    v_mfma_f32_16x16x32_bf16 a[16:19], v[112:115], a[64:67], a[16:19]
    ds_read_b128 a[48:51], v125 offset:0
    v_mfma_f32_16x16x32_bf16 a[32:35], v[116:119], a[64:67], a[32:35]
    v_mfma_f32_16x16x32_bf16 a[4:7], v[108:111], a[68:71], a[4:7]
    ds_read_b128 a[52:55], v125 offset:4096
    v_mfma_f32_16x16x32_bf16 a[20:23], v[112:115], a[68:71], a[20:23]
    v_mfma_f32_16x16x32_bf16 a[36:39], v[116:119], a[68:71], a[36:39]
    ds_read_b128 a[56:59], v125 offset:8192
    v_mfma_f32_16x16x32_bf16 a[8:11], v[108:111], a[72:75], a[8:11]
    v_mfma_f32_16x16x32_bf16 a[24:27], v[112:115], a[72:75], a[24:27]
    ds_read_b128 a[60:63], v125 offset:12288
    v_mfma_f32_16x16x32_bf16 a[40:43], v[116:119], a[72:75], a[40:43]
    v_mfma_f32_16x16x32_bf16 a[12:15], v[108:111], a[76:79], a[12:15]
    v_mfma_f32_16x16x32_bf16 a[28:31], v[112:115], a[76:79], a[28:31]
    v_mfma_f32_16x16x32_bf16 a[44:47], v[116:119], a[76:79], a[44:47]
    s_waitcnt lgkmcnt(0)
    s_waitcnt vmcnt(21)
    s_barrier
    v_mfma_f32_16x16x32_bf16 a[0:3], v[48:51], a[48:51], a[0:3]
    v_mfma_f32_16x16x32_bf16 a[16:19], v[52:55], a[48:51], a[16:19]
    ds_read_b128 a[64:67], v125 offset:16384
    v_mfma_f32_16x16x32_bf16 a[32:35], v[56:59], a[48:51], a[32:35]
    v_mfma_f32_16x16x32_bf16 a[4:7], v[48:51], a[52:55], a[4:7]
    ds_read_b128 a[68:71], v125 offset:20480
    v_mfma_f32_16x16x32_bf16 a[20:23], v[52:55], a[52:55], a[20:23]
    v_mfma_f32_16x16x32_bf16 a[36:39], v[56:59], a[52:55], a[36:39]
    ds_read_b128 a[72:75], v125 offset:24576
    v_mfma_f32_16x16x32_bf16 a[8:11], v[48:51], a[56:59], a[8:11]
    v_mfma_f32_16x16x32_bf16 a[24:27], v[52:55], a[56:59], a[24:27]
    ds_read_b128 a[76:79], v125 offset:28672
    v_mfma_f32_16x16x32_bf16 a[40:43], v[56:59], a[56:59], a[40:43]
    v_mfma_f32_16x16x32_bf16 a[12:15], v[48:51], a[60:63], a[12:15]
    v_mfma_f32_16x16x32_bf16 a[28:31], v[52:55], a[60:63], a[28:31]
    v_mfma_f32_16x16x32_bf16 a[44:47], v[56:59], a[60:63], a[44:47]
    s_waitcnt vmcnt(0)
    v_mfma_f32_16x16x32_bf16 a[80:83], v[20:23], v[16:19], 0
    v_mfma_f32_16x16x32_bf16 a[84:87], v[24:27], v[16:19], 0
    v_mfma_f32_16x16x32_bf16 a[88:91], v[28:31], v[16:19], 0
    v_mfma_f32_16x16x32_bf16 a[92:95], v[36:39], v[32:35], 0
    v_mfma_f32_16x16x32_bf16 a[96:99], v[40:43], v[32:35], 0
    v_mfma_f32_16x16x32_bf16 a[100:103], v[44:47], v[32:35], 0
    s_waitcnt lgkmcnt(0)
    s_barrier
    v_mfma_f32_16x16x32_bf16 a[0:3], v[60:63], a[64:67], a[0:3]
    v_mfma_f32_16x16x32_bf16 a[16:19], v[64:67], a[64:67], a[16:19]
    ds_read_b128 a[48:51], v125 offset:32768
    v_mfma_f32_16x16x32_bf16 a[32:35], v[68:71], a[64:67], a[32:35]
    v_mfma_f32_16x16x32_bf16 a[4:7], v[60:63], a[68:71], a[4:7]
    ds_read_b128 a[52:55], v125 offset:36864
    v_mfma_f32_16x16x32_bf16 a[20:23], v[64:67], a[68:71], a[20:23]
    v_mfma_f32_16x16x32_bf16 a[36:39], v[68:71], a[68:71], a[36:39]
    ds_read_b128 a[56:59], v125 offset:40960
    v_mfma_f32_16x16x32_bf16 a[8:11], v[60:63], a[72:75], a[8:11]
    v_mfma_f32_16x16x32_bf16 a[24:27], v[64:67], a[72:75], a[24:27]
    ds_read_b128 a[60:63], v125 offset:45056
    v_mfma_f32_16x16x32_bf16 a[40:43], v[68:71], a[72:75], a[40:43]
    v_mfma_f32_16x16x32_bf16 a[12:15], v[60:63], a[76:79], a[12:15]
    v_mfma_f32_16x16x32_bf16 a[28:31], v[64:67], a[76:79], a[28:31]
    v_mfma_f32_16x16x32_bf16 a[44:47], v[68:71], a[76:79], a[44:47]
    v_accvgpr_read_b32 v32, a80
    v_accvgpr_read_b32 v33, a81
    v_accvgpr_read_b32 v34, a82
    v_accvgpr_read_b32 v35, a83
    v_accvgpr_read_b32 v36, a84
    v_accvgpr_read_b32 v37, a85
    v_accvgpr_read_b32 v38, a86
    v_accvgpr_read_b32 v39, a87
    v_accvgpr_read_b32 v40, a88
    v_add_u32 v12, 0, v8
    v_lshrrev_b32 v10, 5, v12
    v_lshlrev_b32 v10, 10, v10
    v_bfe_u32 v11, v12, 3, 2
    v_lshl_add_u32 v10, v11, 8, v10
    v_bfe_u32 v11, v12, 2, 1
    v_lshl_add_u32 v10, v11, 3, v10
    v_add_u32 v42, v10, v9
    v_add_u32 v12, 16, v12
    v_lshrrev_b32 v10, 5, v12
    v_lshlrev_b32 v10, 10, v10
    v_bfe_u32 v11, v12, 3, 2
    v_lshl_add_u32 v10, v11, 8, v10
    v_bfe_u32 v11, v12, 2, 1
    v_lshl_add_u32 v10, v11, 3, v10
    v_add_u32 v43, v10, v9
    v_cndmask_b32 v43, v127, v43, s[50:51]
    v_cvt_pk_bf16_f32 v16, v40, v40
    v_lshlrev_b32 v40, 16, v16
    v_add_f32 v40, 0x358637bd, v40
    v_cvt_pk_bf16_f32 v16, v40, v40
    v_lshlrev_b32 v40, 16, v16
    v_rcp_f32 v40, v40
    v_cvt_pk_bf16_f32 v16, v32, v33
    v_lshlrev_b32 v32, 16, v16
    v_and_b32 v33, 0xffff0000, v16
    v_cvt_pk_bf16_f32 v16, v34, v35
    v_lshlrev_b32 v34, 16, v16
    v_and_b32 v35, 0xffff0000, v16
    v_cvt_pk_bf16_f32 v16, v36, v37
    v_lshlrev_b32 v36, 16, v16
    v_and_b32 v37, 0xffff0000, v16
    v_cvt_pk_bf16_f32 v16, v38, v39
    v_lshlrev_b32 v38, 16, v16
    v_and_b32 v39, 0xffff0000, v16
    v_mul_f32 v32, v32, v40
    v_mul_f32 v33, v33, v40
    v_mul_f32 v34, v34, v40
    v_mul_f32 v35, v35, v40
    v_mul_f32 v36, v36, v40
    v_mul_f32 v37, v37, v40
    v_mul_f32 v38, v38, v40
    v_mul_f32 v39, v39, v40
    v_cvt_pk_bf16_f32 v16, v32, v33
    v_cvt_pk_bf16_f32 v17, v34, v35
    v_cvt_pk_bf16_f32 v18, v36, v37
    v_cvt_pk_bf16_f32 v19, v38, v39
    buffer_store_dwordx2 v[16:17], v42, s[20:23], s36 offen
    buffer_store_dwordx2 v[18:19], v43, s[20:23], s36 offen
    s_waitcnt lgkmcnt(0)
    s_barrier
    v_mfma_f32_16x16x32_bf16 a[0:3], v[72:75], a[48:51], a[0:3]
    v_mfma_f32_16x16x32_bf16 a[16:19], v[76:79], a[48:51], a[16:19]
    ds_read_b128 a[64:67], v126 offset:0
    v_mfma_f32_16x16x32_bf16 a[32:35], v[80:83], a[48:51], a[32:35]
    v_mfma_f32_16x16x32_bf16 a[4:7], v[72:75], a[52:55], a[4:7]
    ds_read_b128 a[68:71], v126 offset:4096
    v_mfma_f32_16x16x32_bf16 a[20:23], v[76:79], a[52:55], a[20:23]
    v_mfma_f32_16x16x32_bf16 a[36:39], v[80:83], a[52:55], a[36:39]
    ds_read_b128 a[72:75], v126 offset:8192
    v_mfma_f32_16x16x32_bf16 a[8:11], v[72:75], a[56:59], a[8:11]
    v_mfma_f32_16x16x32_bf16 a[24:27], v[76:79], a[56:59], a[24:27]
    ds_read_b128 a[76:79], v126 offset:12288
    v_mfma_f32_16x16x32_bf16 a[40:43], v[80:83], a[56:59], a[40:43]
    v_mfma_f32_16x16x32_bf16 a[12:15], v[72:75], a[60:63], a[12:15]
    v_mfma_f32_16x16x32_bf16 a[28:31], v[76:79], a[60:63], a[28:31]
    v_mfma_f32_16x16x32_bf16 a[44:47], v[80:83], a[60:63], a[44:47]
    v_accvgpr_read_b32 v32, a92
    v_accvgpr_read_b32 v33, a93
    v_accvgpr_read_b32 v34, a94
    v_accvgpr_read_b32 v35, a95
    v_accvgpr_read_b32 v36, a96
    v_accvgpr_read_b32 v37, a97
    v_accvgpr_read_b32 v38, a98
    v_accvgpr_read_b32 v39, a99
    v_accvgpr_read_b32 v40, a100
    v_add_u32 v12, 20, v8
    v_lshrrev_b32 v10, 5, v12
    v_lshlrev_b32 v10, 10, v10
    v_bfe_u32 v11, v12, 3, 2
    v_lshl_add_u32 v10, v11, 8, v10
    v_bfe_u32 v11, v12, 2, 1
    v_lshl_add_u32 v10, v11, 3, v10
    v_add_u32 v42, v10, v9
    v_add_u32 v12, 16, v12
    v_lshrrev_b32 v10, 5, v12
    v_lshlrev_b32 v10, 10, v10
    v_bfe_u32 v11, v12, 3, 2
    v_lshl_add_u32 v10, v11, 8, v10
    v_bfe_u32 v11, v12, 2, 1
    v_lshl_add_u32 v10, v11, 3, v10
    v_add_u32 v43, v10, v9
    v_cndmask_b32 v43, v127, v43, s[50:51]
    v_cvt_pk_bf16_f32 v20, v40, v40
    v_lshlrev_b32 v40, 16, v20
    v_add_f32 v40, 0x358637bd, v40
    v_cvt_pk_bf16_f32 v20, v40, v40
    v_lshlrev_b32 v40, 16, v20
    v_rcp_f32 v40, v40
    v_cvt_pk_bf16_f32 v20, v32, v33
    v_lshlrev_b32 v32, 16, v20
    v_and_b32 v33, 0xffff0000, v20
    v_cvt_pk_bf16_f32 v20, v34, v35
    v_lshlrev_b32 v34, 16, v20
    v_and_b32 v35, 0xffff0000, v20
    v_cvt_pk_bf16_f32 v20, v36, v37
    v_lshlrev_b32 v36, 16, v20
    v_and_b32 v37, 0xffff0000, v20
    v_cvt_pk_bf16_f32 v20, v38, v39
    v_lshlrev_b32 v38, 16, v20
    v_and_b32 v39, 0xffff0000, v20
    v_mul_f32 v32, v32, v40
    v_mul_f32 v33, v33, v40
    v_mul_f32 v34, v34, v40
    v_mul_f32 v35, v35, v40
    v_mul_f32 v36, v36, v40
    v_mul_f32 v37, v37, v40
    v_mul_f32 v38, v38, v40
    v_mul_f32 v39, v39, v40
    v_cvt_pk_bf16_f32 v20, v32, v33
    v_cvt_pk_bf16_f32 v21, v34, v35
    v_cvt_pk_bf16_f32 v22, v36, v37
    v_cvt_pk_bf16_f32 v23, v38, v39
    buffer_store_dwordx2 v[20:21], v42, s[20:23], s36 offen
    buffer_store_dwordx2 v[22:23], v43, s[20:23], s36 offen
    buffer_load_dwordx2 v[24:25], v14, s[20:23], s47 offen offset:0
    buffer_load_dwordx2 v[26:27], v14, s[20:23], s47 offen offset:32
    buffer_load_dwordx2 v[28:29], v14, s[20:23], s47 offen offset:64
    buffer_load_ushort v30, v13, s[16:19], 0 offen
    s_waitcnt lgkmcnt(0)
    v_mfma_f32_16x16x32_bf16 a[0:3], v[84:87], a[64:67], a[0:3]
    v_mfma_f32_16x16x32_bf16 a[16:19], v[88:91], a[64:67], a[16:19]
    v_mfma_f32_16x16x32_bf16 a[32:35], v[92:95], a[64:67], a[32:35]
    v_mfma_f32_16x16x32_bf16 a[4:7], v[84:87], a[68:71], a[4:7]
    v_mfma_f32_16x16x32_bf16 a[20:23], v[88:91], a[68:71], a[20:23]
    v_mfma_f32_16x16x32_bf16 a[36:39], v[92:95], a[68:71], a[36:39]
    v_mfma_f32_16x16x32_bf16 a[8:11], v[84:87], a[72:75], a[8:11]
    v_mfma_f32_16x16x32_bf16 a[24:27], v[88:91], a[72:75], a[24:27]
    v_mfma_f32_16x16x32_bf16 a[40:43], v[92:95], a[72:75], a[40:43]
    v_mfma_f32_16x16x32_bf16 a[12:15], v[84:87], a[76:79], a[12:15]
    v_mfma_f32_16x16x32_bf16 a[28:31], v[88:91], a[76:79], a[28:31]
    v_mfma_f32_16x16x32_bf16 a[44:47], v[92:95], a[76:79], a[44:47]
    v_lshlrev_b32 v4, 4, v1
    s_mul_i32 s33, s28, 12288
    v_add_u32 v5, s33, v4
    s_mul_i32 s33, s30, 49152
    s_lshl_b32 s34, s29, 10
    s_add_u32 s33, s33, s34
    v_add_u32 v6, s33, v4
    s_barrier
    ds_write_b128 v5, a[0:3] offset:0
    ds_write_b128 v5, a[4:7] offset:1024
    ds_write_b128 v5, a[8:11] offset:2048
    ds_write_b128 v5, a[12:15] offset:3072
    ds_write_b128 v5, a[16:19] offset:4096
    ds_write_b128 v5, a[20:23] offset:5120
    ds_write_b128 v5, a[24:27] offset:6144
    ds_write_b128 v5, a[28:31] offset:7168
    ds_write_b128 v5, a[32:35] offset:8192
    ds_write_b128 v5, a[36:39] offset:9216
    ds_write_b128 v5, a[40:43] offset:10240
    ds_write_b128 v5, a[44:47] offset:11264
    s_waitcnt lgkmcnt(0)
    s_barrier
    ds_read_b128 v[48:51], v6 offset:0
    ds_read_b128 v[52:55], v6 offset:4096
    ds_read_b128 v[56:59], v6 offset:8192
    ds_read_b128 v[60:63], v6 offset:12288
    ds_read_b128 v[64:67], v6 offset:16384
    ds_read_b128 v[68:71], v6 offset:20480
    ds_read_b128 v[72:75], v6 offset:24576
    ds_read_b128 v[76:79], v6 offset:28672
    ds_read_b128 v[80:83], v6 offset:32768
    ds_read_b128 v[84:87], v6 offset:36864
    ds_read_b128 v[88:91], v6 offset:40960
    ds_read_b128 v[92:95], v6 offset:45056
    s_waitcnt lgkmcnt(0)
    v_add_f32 v48, v48, v60
    v_add_f32 v49, v49, v61
    v_add_f32 v50, v50, v62
    v_add_f32 v51, v51, v63
    v_add_f32 v52, v52, v64
    v_add_f32 v53, v53, v65
    v_add_f32 v54, v54, v66
    v_add_f32 v55, v55, v67
    v_add_f32 v56, v56, v68
    v_add_f32 v57, v57, v69
    v_add_f32 v58, v58, v70
    v_add_f32 v59, v59, v71
    v_add_f32 v48, v48, v72
    v_add_f32 v49, v49, v73
    v_add_f32 v50, v50, v74
    v_add_f32 v51, v51, v75
    v_add_f32 v52, v52, v76
    v_add_f32 v53, v53, v77
    v_add_f32 v54, v54, v78
    v_add_f32 v55, v55, v79
    v_add_f32 v56, v56, v80
    v_add_f32 v57, v57, v81
    v_add_f32 v58, v58, v82
    v_add_f32 v59, v59, v83
    v_add_f32 v48, v48, v84
    v_add_f32 v49, v49, v85
    v_add_f32 v50, v50, v86
    v_add_f32 v51, v51, v87
    v_add_f32 v52, v52, v88
    v_add_f32 v53, v53, v89
    v_add_f32 v54, v54, v90
    v_add_f32 v55, v55, v91
    v_add_f32 v56, v56, v92
    v_add_f32 v57, v57, v93
    v_add_f32 v58, v58, v94
    v_add_f32 v59, v59, v95
    s_waitcnt vmcnt(0)
    v_lshlrev_b32 v30, 16, v30
    v_cvt_pk_bf16_f32 v100, v48, v49
    v_lshlrev_b32 v48, 16, v100
    v_and_b32 v49, 0xffff0000, v100
    v_cvt_pk_bf16_f32 v101, v50, v51
    v_lshlrev_b32 v50, 16, v101
    v_and_b32 v51, 0xffff0000, v101
    v_cvt_pk_bf16_f32 v102, v52, v53
    v_lshlrev_b32 v52, 16, v102
    v_and_b32 v53, 0xffff0000, v102
    v_cvt_pk_bf16_f32 v103, v54, v55
    v_lshlrev_b32 v54, 16, v103
    v_and_b32 v55, 0xffff0000, v103
    v_cvt_pk_bf16_f32 v104, v56, v57
    v_lshlrev_b32 v56, 16, v104
    v_and_b32 v57, 0xffff0000, v104
    v_cvt_pk_bf16_f32 v105, v58, v59
    v_lshlrev_b32 v58, 16, v105
    v_and_b32 v59, 0xffff0000, v105
    v_add_f32 v48, v48, v30
    v_add_f32 v49, v49, v30
    v_add_f32 v50, v50, v30
    v_add_f32 v51, v51, v30
    v_add_f32 v52, v52, v30
    v_add_f32 v53, v53, v30
    v_add_f32 v54, v54, v30
    v_add_f32 v55, v55, v30
    v_add_f32 v56, v56, v30
    v_add_f32 v57, v57, v30
    v_add_f32 v58, v58, v30
    v_add_f32 v59, v59, v30
    v_cvt_pk_bf16_f32 v100, v48, v49
    v_lshlrev_b32 v48, 16, v100
    v_and_b32 v49, 0xffff0000, v100
    v_cvt_pk_bf16_f32 v101, v50, v51
    v_lshlrev_b32 v50, 16, v101
    v_and_b32 v51, 0xffff0000, v101
    v_cvt_pk_bf16_f32 v102, v52, v53
    v_lshlrev_b32 v52, 16, v102
    v_and_b32 v53, 0xffff0000, v102
    v_cvt_pk_bf16_f32 v103, v54, v55
    v_lshlrev_b32 v54, 16, v103
    v_and_b32 v55, 0xffff0000, v103
    v_cvt_pk_bf16_f32 v104, v56, v57
    v_lshlrev_b32 v56, 16, v104
    v_and_b32 v57, 0xffff0000, v104
    v_cvt_pk_bf16_f32 v105, v58, v59
    v_lshlrev_b32 v58, 16, v105
    v_and_b32 v59, 0xffff0000, v105
    v_lshlrev_b32 v100, 16, v24
    v_and_b32 v101, 0xffff0000, v24
    v_lshlrev_b32 v102, 16, v25
    v_and_b32 v103, 0xffff0000, v25
    v_lshlrev_b32 v104, 16, v26
    v_and_b32 v105, 0xffff0000, v26
    v_lshlrev_b32 v106, 16, v27
    v_and_b32 v107, 0xffff0000, v27
    v_lshlrev_b32 v108, 16, v28
    v_and_b32 v109, 0xffff0000, v28
    v_lshlrev_b32 v110, 16, v29
    v_and_b32 v111, 0xffff0000, v29
    v_mul_f32 v48, v48, v100
    v_mul_f32 v49, v49, v101
    v_mul_f32 v50, v50, v102
    v_mul_f32 v51, v51, v103
    v_mul_f32 v52, v52, v104
    v_mul_f32 v53, v53, v105
    v_mul_f32 v54, v54, v106
    v_mul_f32 v55, v55, v107
    v_mul_f32 v56, v56, v108
    v_mul_f32 v57, v57, v109
    v_mul_f32 v58, v58, v110
    v_mul_f32 v59, v59, v111
    v_cvt_pk_bf16_f32 v24, v48, v49
    v_cvt_pk_bf16_f32 v25, v50, v51
    v_cvt_pk_bf16_f32 v26, v52, v53
    v_cvt_pk_bf16_f32 v27, v54, v55
    v_cvt_pk_bf16_f32 v28, v56, v57
    v_cvt_pk_bf16_f32 v29, v58, v59
    buffer_store_dwordx2 v[24:25], v15, s[20:23], s48 offen offset:0
    buffer_store_dwordx2 v[26:27], v15, s[20:23], s48 offen offset:512
    buffer_store_dwordx2 v[28:29], v15, s[20:23], s48 offen offset:1024
k3_done:
    s_endpgm
.globl k4_kernel
.p2align 8
.type k4_kernel,@function
k4_kernel:
    s_cmp_ge_u32 s2, 256
    s_cbranch_scc1 k4_done
    s_load_dwordx2 s[4:5], s[0:1], 0
    s_load_dwordx2 s[6:7], s[0:1], 64
    s_load_dwordx2 s[10:11], s[0:1], 80
    v_lshrrev_b32 v2, 6, v0
    v_and_b32 v1, 63, v0
    v_readfirstlane_b32 s28, v2
    v_and_b32 v2, 15, v1
    v_lshrrev_b32 v3, 4, v1
    s_and_b32 s33, s2, 7
    s_lshr_b32 s26, s2, 3
    s_lshr_b32 s24, s33, 1
    s_lshl_b32 s24, s24, 3
    s_lshr_b32 s25, s26, 2
    s_add_u32 s24, s24, s25
    s_and_b32 s25, s33, 1
    s_lshl_b32 s25, s25, 2
    s_and_b32 s34, s26, 3
    s_add_u32 s25, s25, s34
    s_and_b32 s29, s28, 3
    s_lshr_b32 s30, s28, 2
    v_lshlrev_b32 v4, 4, v1
    s_lshl_b32 s34, s29, 10
    s_mul_i32 s33, s30, 20480
    s_add_u32 s34, s34, s33
    s_mul_i32 s33, s25, 225280
    s_add_u32 s33, s33, s34
    s_add_u32 s33, s33, 17432576
    v_add_u32 v5, s33, v4
    s_mul_i32 s33, s24, 180224
    s_add_u32 s33, s33, s34
    s_add_u32 s33, s33, 19398656
    v_add_u32 v10, s33, v4
    v_add_u32 v6, 45056, v5
    v_add_u32 v7, 90112, v5
    v_add_u32 v8, 135168, v5
    v_add_u32 v9, 180224, v5
    v_add_u32 v11, 45056, v10
    v_add_u32 v12, 90112, v10
    v_add_u32 v13, 135168, v10
    s_waitcnt lgkmcnt(0)
    s_mov_b32 s20, s10
    s_and_b32 s21, s11, 0xffff
    s_mov_b32 s22, 25182208
    s_mov_b32 s23, 0x00020000
    s_mov_b32 s44, 0
    buffer_load_dwordx4 a[80:83], v5, s[20:23], s44 offen
    buffer_load_dwordx4 a[84:87], v6, s[20:23], s44 offen
    buffer_load_dwordx4 a[88:91], v7, s[20:23], s44 offen
    buffer_load_dwordx4 a[92:95], v8, s[20:23], s44 offen
    buffer_load_dwordx4 a[96:99], v9, s[20:23], s44 offen
    buffer_load_dwordx4 a[100:103], v10, s[20:23], s44 offen
    buffer_load_dwordx4 a[104:107], v11, s[20:23], s44 offen
    buffer_load_dwordx4 a[108:111], v12, s[20:23], s44 offen
    buffer_load_dwordx4 a[112:115], v13, s[20:23], s44 offen
    s_mov_b32 s44, 4096
    buffer_load_dwordx4 v[20:23], v5, s[20:23], s44 offen
    buffer_load_dwordx4 v[24:27], v6, s[20:23], s44 offen
    buffer_load_dwordx4 v[28:31], v7, s[20:23], s44 offen
    buffer_load_dwordx4 v[32:35], v8, s[20:23], s44 offen
    buffer_load_dwordx4 v[36:39], v9, s[20:23], s44 offen
    buffer_load_dwordx4 v[40:43], v10, s[20:23], s44 offen
    buffer_load_dwordx4 v[44:47], v11, s[20:23], s44 offen
    buffer_load_dwordx4 v[48:51], v12, s[20:23], s44 offen
    buffer_load_dwordx4 v[52:55], v13, s[20:23], s44 offen
    s_mov_b32 s44, 8192
    buffer_load_dwordx4 v[56:59], v5, s[20:23], s44 offen
    buffer_load_dwordx4 v[60:63], v6, s[20:23], s44 offen
    buffer_load_dwordx4 v[64:67], v7, s[20:23], s44 offen
    buffer_load_dwordx4 v[68:71], v8, s[20:23], s44 offen
    buffer_load_dwordx4 v[72:75], v9, s[20:23], s44 offen
    buffer_load_dwordx4 v[76:79], v10, s[20:23], s44 offen
    buffer_load_dwordx4 v[80:83], v11, s[20:23], s44 offen
    buffer_load_dwordx4 v[84:87], v12, s[20:23], s44 offen
    buffer_load_dwordx4 v[88:91], v13, s[20:23], s44 offen
    s_mov_b32 s44, 12288
    buffer_load_dwordx4 v[92:95], v5, s[20:23], s44 offen
    buffer_load_dwordx4 v[96:99], v6, s[20:23], s44 offen
    buffer_load_dwordx4 v[100:103], v7, s[20:23], s44 offen
    buffer_load_dwordx4 v[104:107], v8, s[20:23], s44 offen
    buffer_load_dwordx4 v[108:111], v9, s[20:23], s44 offen
    buffer_load_dwordx4 v[112:115], v10, s[20:23], s44 offen
    buffer_load_dwordx4 v[116:119], v11, s[20:23], s44 offen
    buffer_load_dwordx4 v[120:123], v12, s[20:23], s44 offen
    buffer_load_dwordx4 v[124:127], v13, s[20:23], s44 offen
    s_mov_b32 s12, s4
    s_and_b32 s13, s5, 0xffff
    s_mov_b32 s14, 2621440
    s_mov_b32 s15, 0x00020000
    s_mov_b32 s16, s6
    s_and_b32 s17, s7, 0xffff
    s_mov_b32 s18, 2621440
    s_mov_b32 s19, 0x00020000
    s_lshl_b32 s33, s24, 6
    s_lshl_b32 s34, s29, 4
    s_add_u32 s33, s33, s34
    v_add_u32 v14, s33, v2
    s_movk_i32 s34, 1280
    v_mul_lo_u32 v14, v14, s34
    v_lshlrev_b32 v15, 3, v3
    v_add_u32 v14, v14, v15
    s_mul_i32 s46, s25, 160
    s_mul_i32 s33, s30, 96
    s_add_u32 s46, s46, s33
    s_waitcnt vmcnt(27)
    v_mfma_f32_16x16x32_bf16 a[0:3], a[80:83], a[100:103], 0
    v_mfma_f32_16x16x32_bf16 a[16:19], a[84:87], a[100:103], 0
    v_mfma_f32_16x16x32_bf16 a[32:35], a[88:91], a[100:103], 0
    v_mfma_f32_16x16x32_bf16 a[48:51], a[92:95], a[100:103], 0
    v_mfma_f32_16x16x32_bf16 a[64:67], a[96:99], a[100:103], 0
    v_mfma_f32_16x16x32_bf16 a[4:7], a[80:83], a[104:107], 0
    v_mfma_f32_16x16x32_bf16 a[20:23], a[84:87], a[104:107], 0
    v_mfma_f32_16x16x32_bf16 a[36:39], a[88:91], a[104:107], 0
    v_mfma_f32_16x16x32_bf16 a[52:55], a[92:95], a[104:107], 0
    v_mfma_f32_16x16x32_bf16 a[68:71], a[96:99], a[104:107], 0
    v_mfma_f32_16x16x32_bf16 a[8:11], a[80:83], a[108:111], 0
    v_mfma_f32_16x16x32_bf16 a[24:27], a[84:87], a[108:111], 0
    v_mfma_f32_16x16x32_bf16 a[40:43], a[88:91], a[108:111], 0
    v_mfma_f32_16x16x32_bf16 a[56:59], a[92:95], a[108:111], 0
    v_mfma_f32_16x16x32_bf16 a[72:75], a[96:99], a[108:111], 0
    v_mfma_f32_16x16x32_bf16 a[12:15], a[80:83], a[112:115], 0
    v_mfma_f32_16x16x32_bf16 a[28:31], a[84:87], a[112:115], 0
    v_mfma_f32_16x16x32_bf16 a[44:47], a[88:91], a[112:115], 0
    v_mfma_f32_16x16x32_bf16 a[60:63], a[92:95], a[112:115], 0
    v_mfma_f32_16x16x32_bf16 a[76:79], a[96:99], a[112:115], 0
    s_waitcnt vmcnt(18)
    v_mfma_f32_16x16x32_bf16 a[0:3], v[20:23], v[40:43], a[0:3]
    s_mov_b32 s44, 16384
    buffer_load_dwordx4 a[80:83], v5, s[20:23], s44 offen
    buffer_load_dwordx4 a[84:87], v6, s[20:23], s44 offen
    buffer_load_dwordx4 a[88:91], v7, s[20:23], s44 offen
    buffer_load_dwordx4 a[92:95], v8, s[20:23], s44 offen
    buffer_load_dwordx4 a[96:99], v9, s[20:23], s44 offen
    buffer_load_dwordx4 a[100:103], v10, s[20:23], s44 offen
    buffer_load_dwordx4 a[104:107], v11, s[20:23], s44 offen
    buffer_load_dwordx4 a[108:111], v12, s[20:23], s44 offen
    buffer_load_dwordx4 a[112:115], v13, s[20:23], s44 offen
    v_mfma_f32_16x16x32_bf16 a[16:19], v[24:27], v[40:43], a[16:19]
    v_mfma_f32_16x16x32_bf16 a[32:35], v[28:31], v[40:43], a[32:35]
    v_mfma_f32_16x16x32_bf16 a[48:51], v[32:35], v[40:43], a[48:51]
    v_mfma_f32_16x16x32_bf16 a[64:67], v[36:39], v[40:43], a[64:67]
    v_mfma_f32_16x16x32_bf16 a[4:7], v[20:23], v[44:47], a[4:7]
    v_mfma_f32_16x16x32_bf16 a[20:23], v[24:27], v[44:47], a[20:23]
    v_mfma_f32_16x16x32_bf16 a[36:39], v[28:31], v[44:47], a[36:39]
    v_mfma_f32_16x16x32_bf16 a[52:55], v[32:35], v[44:47], a[52:55]
    v_mfma_f32_16x16x32_bf16 a[68:71], v[36:39], v[44:47], a[68:71]
    v_mfma_f32_16x16x32_bf16 a[8:11], v[20:23], v[48:51], a[8:11]
    v_mfma_f32_16x16x32_bf16 a[24:27], v[24:27], v[48:51], a[24:27]
    v_mfma_f32_16x16x32_bf16 a[40:43], v[28:31], v[48:51], a[40:43]
    v_mfma_f32_16x16x32_bf16 a[56:59], v[32:35], v[48:51], a[56:59]
    v_mfma_f32_16x16x32_bf16 a[72:75], v[36:39], v[48:51], a[72:75]
    v_mfma_f32_16x16x32_bf16 a[12:15], v[20:23], v[52:55], a[12:15]
    v_mfma_f32_16x16x32_bf16 a[28:31], v[24:27], v[52:55], a[28:31]
    v_mfma_f32_16x16x32_bf16 a[44:47], v[28:31], v[52:55], a[44:47]
    v_mfma_f32_16x16x32_bf16 a[60:63], v[32:35], v[52:55], a[60:63]
    v_mfma_f32_16x16x32_bf16 a[76:79], v[36:39], v[52:55], a[76:79]
    s_waitcnt vmcnt(18)
    v_mfma_f32_16x16x32_bf16 a[0:3], v[56:59], v[76:79], a[0:3]
    s_mov_b32 s44, 20480
    buffer_load_dwordx4 v[20:23], v5, s[20:23], s44 offen
    buffer_load_dwordx4 v[24:27], v6, s[20:23], s44 offen
    buffer_load_dwordx4 v[28:31], v7, s[20:23], s44 offen
    buffer_load_dwordx4 v[32:35], v8, s[20:23], s44 offen
    buffer_load_dwordx4 v[36:39], v9, s[20:23], s44 offen
    buffer_load_dwordx4 v[40:43], v10, s[20:23], s44 offen
    buffer_load_dwordx4 v[44:47], v11, s[20:23], s44 offen
    buffer_load_dwordx4 v[48:51], v12, s[20:23], s44 offen
    buffer_load_dwordx4 v[52:55], v13, s[20:23], s44 offen
    v_mfma_f32_16x16x32_bf16 a[16:19], v[60:63], v[76:79], a[16:19]
    v_mfma_f32_16x16x32_bf16 a[32:35], v[64:67], v[76:79], a[32:35]
    v_mfma_f32_16x16x32_bf16 a[48:51], v[68:71], v[76:79], a[48:51]
    v_mfma_f32_16x16x32_bf16 a[64:67], v[72:75], v[76:79], a[64:67]
    v_mfma_f32_16x16x32_bf16 a[4:7], v[56:59], v[80:83], a[4:7]
    v_mfma_f32_16x16x32_bf16 a[20:23], v[60:63], v[80:83], a[20:23]
    v_mfma_f32_16x16x32_bf16 a[36:39], v[64:67], v[80:83], a[36:39]
    v_mfma_f32_16x16x32_bf16 a[52:55], v[68:71], v[80:83], a[52:55]
    v_mfma_f32_16x16x32_bf16 a[68:71], v[72:75], v[80:83], a[68:71]
    v_mfma_f32_16x16x32_bf16 a[8:11], v[56:59], v[84:87], a[8:11]
    v_mfma_f32_16x16x32_bf16 a[24:27], v[60:63], v[84:87], a[24:27]
    v_mfma_f32_16x16x32_bf16 a[40:43], v[64:67], v[84:87], a[40:43]
    v_mfma_f32_16x16x32_bf16 a[56:59], v[68:71], v[84:87], a[56:59]
    v_mfma_f32_16x16x32_bf16 a[72:75], v[72:75], v[84:87], a[72:75]
    v_mfma_f32_16x16x32_bf16 a[12:15], v[56:59], v[88:91], a[12:15]
    v_mfma_f32_16x16x32_bf16 a[28:31], v[60:63], v[88:91], a[28:31]
    v_mfma_f32_16x16x32_bf16 a[44:47], v[64:67], v[88:91], a[44:47]
    v_mfma_f32_16x16x32_bf16 a[60:63], v[68:71], v[88:91], a[60:63]
    v_mfma_f32_16x16x32_bf16 a[76:79], v[72:75], v[88:91], a[76:79]
    s_waitcnt vmcnt(18)
    v_mfma_f32_16x16x32_bf16 a[0:3], v[92:95], v[112:115], a[0:3]
    v_mfma_f32_16x16x32_bf16 a[16:19], v[96:99], v[112:115], a[16:19]
    v_mfma_f32_16x16x32_bf16 a[32:35], v[100:103], v[112:115], a[32:35]
    v_mfma_f32_16x16x32_bf16 a[48:51], v[104:107], v[112:115], a[48:51]
    v_mfma_f32_16x16x32_bf16 a[64:67], v[108:111], v[112:115], a[64:67]
    v_mfma_f32_16x16x32_bf16 a[4:7], v[92:95], v[116:119], a[4:7]
    v_mfma_f32_16x16x32_bf16 a[20:23], v[96:99], v[116:119], a[20:23]
    v_mfma_f32_16x16x32_bf16 a[36:39], v[100:103], v[116:119], a[36:39]
    v_mfma_f32_16x16x32_bf16 a[52:55], v[104:107], v[116:119], a[52:55]
    v_mfma_f32_16x16x32_bf16 a[68:71], v[108:111], v[116:119], a[68:71]
    v_mfma_f32_16x16x32_bf16 a[8:11], v[92:95], v[120:123], a[8:11]
    v_mfma_f32_16x16x32_bf16 a[24:27], v[96:99], v[120:123], a[24:27]
    v_mfma_f32_16x16x32_bf16 a[40:43], v[100:103], v[120:123], a[40:43]
    v_mfma_f32_16x16x32_bf16 a[56:59], v[104:107], v[120:123], a[56:59]
    v_mfma_f32_16x16x32_bf16 a[72:75], v[108:111], v[120:123], a[72:75]
    v_mfma_f32_16x16x32_bf16 a[12:15], v[92:95], v[124:127], a[12:15]
    v_mfma_f32_16x16x32_bf16 a[28:31], v[96:99], v[124:127], a[28:31]
    v_mfma_f32_16x16x32_bf16 a[44:47], v[100:103], v[124:127], a[44:47]
    v_mfma_f32_16x16x32_bf16 a[60:63], v[104:107], v[124:127], a[60:63]
    v_mfma_f32_16x16x32_bf16 a[76:79], v[108:111], v[124:127], a[76:79]
    s_waitcnt vmcnt(9)
    v_mfma_f32_16x16x32_bf16 a[0:3], a[80:83], a[100:103], a[0:3]
    v_mfma_f32_16x16x32_bf16 a[16:19], a[84:87], a[100:103], a[16:19]
    v_mfma_f32_16x16x32_bf16 a[32:35], a[88:91], a[100:103], a[32:35]
    v_mfma_f32_16x16x32_bf16 a[48:51], a[92:95], a[100:103], a[48:51]
    v_mfma_f32_16x16x32_bf16 a[64:67], a[96:99], a[100:103], a[64:67]
    v_mfma_f32_16x16x32_bf16 a[4:7], a[80:83], a[104:107], a[4:7]
    v_mfma_f32_16x16x32_bf16 a[20:23], a[84:87], a[104:107], a[20:23]
    v_mfma_f32_16x16x32_bf16 a[36:39], a[88:91], a[104:107], a[36:39]
    v_mfma_f32_16x16x32_bf16 a[52:55], a[92:95], a[104:107], a[52:55]
    v_mfma_f32_16x16x32_bf16 a[68:71], a[96:99], a[104:107], a[68:71]
    v_mfma_f32_16x16x32_bf16 a[8:11], a[80:83], a[108:111], a[8:11]
    v_mfma_f32_16x16x32_bf16 a[24:27], a[84:87], a[108:111], a[24:27]
    v_mfma_f32_16x16x32_bf16 a[40:43], a[88:91], a[108:111], a[40:43]
    v_mfma_f32_16x16x32_bf16 a[56:59], a[92:95], a[108:111], a[56:59]
    v_mfma_f32_16x16x32_bf16 a[72:75], a[96:99], a[108:111], a[72:75]
    v_mfma_f32_16x16x32_bf16 a[12:15], a[80:83], a[112:115], a[12:15]
    v_mfma_f32_16x16x32_bf16 a[28:31], a[84:87], a[112:115], a[28:31]
    v_mfma_f32_16x16x32_bf16 a[44:47], a[88:91], a[112:115], a[44:47]
    v_mfma_f32_16x16x32_bf16 a[60:63], a[92:95], a[112:115], a[60:63]
    v_mfma_f32_16x16x32_bf16 a[76:79], a[96:99], a[112:115], a[76:79]
    s_cmp_eq_u32 s30, 0
    s_cbranch_scc1 k4_skip5
    s_waitcnt vmcnt(0)
    v_mfma_f32_16x16x32_bf16 a[0:3], v[20:23], v[40:43], a[0:3]
    v_mfma_f32_16x16x32_bf16 a[16:19], v[24:27], v[40:43], a[16:19]
    v_mfma_f32_16x16x32_bf16 a[32:35], v[28:31], v[40:43], a[32:35]
    v_mfma_f32_16x16x32_bf16 a[48:51], v[32:35], v[40:43], a[48:51]
    v_mfma_f32_16x16x32_bf16 a[64:67], v[36:39], v[40:43], a[64:67]
    v_mfma_f32_16x16x32_bf16 a[4:7], v[20:23], v[44:47], a[4:7]
    v_mfma_f32_16x16x32_bf16 a[20:23], v[24:27], v[44:47], a[20:23]
    v_mfma_f32_16x16x32_bf16 a[36:39], v[28:31], v[44:47], a[36:39]
    v_mfma_f32_16x16x32_bf16 a[52:55], v[32:35], v[44:47], a[52:55]
    v_mfma_f32_16x16x32_bf16 a[68:71], v[36:39], v[44:47], a[68:71]
    v_mfma_f32_16x16x32_bf16 a[8:11], v[20:23], v[48:51], a[8:11]
    v_mfma_f32_16x16x32_bf16 a[24:27], v[24:27], v[48:51], a[24:27]
    v_mfma_f32_16x16x32_bf16 a[40:43], v[28:31], v[48:51], a[40:43]
    v_mfma_f32_16x16x32_bf16 a[56:59], v[32:35], v[48:51], a[56:59]
    v_mfma_f32_16x16x32_bf16 a[72:75], v[36:39], v[48:51], a[72:75]
    v_mfma_f32_16x16x32_bf16 a[12:15], v[20:23], v[52:55], a[12:15]
    v_mfma_f32_16x16x32_bf16 a[28:31], v[24:27], v[52:55], a[28:31]
    v_mfma_f32_16x16x32_bf16 a[44:47], v[28:31], v[52:55], a[44:47]
    v_mfma_f32_16x16x32_bf16 a[60:63], v[32:35], v[52:55], a[60:63]
    v_mfma_f32_16x16x32_bf16 a[76:79], v[36:39], v[52:55], a[76:79]
k4_skip5:
    s_waitcnt vmcnt(0)
    buffer_load_dwordx2 v[116:117], v14, s[12:15], s46 offen offset:0
    buffer_load_dwordx2 v[118:119], v14, s[12:15], s46 offen offset:32
    buffer_load_dwordx2 v[120:121], v14, s[12:15], s46 offen offset:64
    v_lshlrev_b32 v4, 4, v1
    s_mul_i32 s33, s28, 20480
    v_add_u32 v5, s33, v4
    s_lshl_b32 s33, s29, 10
    s_mul_i32 s34, s30, 12288
    s_add_u32 s33, s33, s34
    v_add_u32 v6, s33, v4
    v_add_u32 v7, 40960, v6
    v_add_u32 v8, 81920, v6
    v_add_u32 v9, 122880, v6
    s_nop 4
    ds_write_b128 v5, a[0:3] offset:0
    ds_write_b128 v5, a[4:7] offset:1024
    ds_write_b128 v5, a[8:11] offset:2048
    ds_write_b128 v5, a[12:15] offset:3072
    ds_write_b128 v5, a[16:19] offset:4096
    ds_write_b128 v5, a[20:23] offset:5120
    ds_write_b128 v5, a[24:27] offset:6144
    ds_write_b128 v5, a[28:31] offset:7168
    ds_write_b128 v5, a[32:35] offset:8192
    ds_write_b128 v5, a[36:39] offset:9216
    ds_write_b128 v5, a[40:43] offset:10240
    ds_write_b128 v5, a[44:47] offset:11264
    ds_write_b128 v5, a[48:51] offset:12288
    ds_write_b128 v5, a[52:55] offset:13312
    ds_write_b128 v5, a[56:59] offset:14336
    ds_write_b128 v5, a[60:63] offset:15360
    ds_write_b128 v5, a[64:67] offset:16384
    ds_write_b128 v5, a[68:71] offset:17408
    ds_write_b128 v5, a[72:75] offset:18432
    ds_write_b128 v5, a[76:79] offset:19456
    s_waitcnt lgkmcnt(0)
    s_barrier
    ds_read_b128 v[20:23], v6 offset:0
    ds_read_b128 v[24:27], v6 offset:4096
    ds_read_b128 v[28:31], v6 offset:8192
    ds_read_b128 v[32:35], v6 offset:20480
    ds_read_b128 v[36:39], v6 offset:24576
    ds_read_b128 v[40:43], v6 offset:28672
    ds_read_b128 v[44:47], v7 offset:0
    ds_read_b128 v[48:51], v7 offset:4096
    ds_read_b128 v[52:55], v7 offset:8192
    ds_read_b128 v[56:59], v7 offset:20480
    ds_read_b128 v[60:63], v7 offset:24576
    ds_read_b128 v[64:67], v7 offset:28672
    ds_read_b128 v[68:71], v8 offset:0
    ds_read_b128 v[72:75], v8 offset:4096
    ds_read_b128 v[76:79], v8 offset:8192
    ds_read_b128 v[80:83], v8 offset:20480
    ds_read_b128 v[84:87], v8 offset:24576
    ds_read_b128 v[88:91], v8 offset:28672
    ds_read_b128 v[92:95], v9 offset:0
    ds_read_b128 v[96:99], v9 offset:4096
    ds_read_b128 v[100:103], v9 offset:8192
    ds_read_b128 v[104:107], v9 offset:20480
    ds_read_b128 v[108:111], v9 offset:24576
    ds_read_b128 v[112:115], v9 offset:28672
    s_waitcnt lgkmcnt(0)
    v_add_f32 v20, v20, v32
    v_add_f32 v21, v21, v33
    v_add_f32 v22, v22, v34
    v_add_f32 v23, v23, v35
    v_add_f32 v24, v24, v36
    v_add_f32 v25, v25, v37
    v_add_f32 v26, v26, v38
    v_add_f32 v27, v27, v39
    v_add_f32 v28, v28, v40
    v_add_f32 v29, v29, v41
    v_add_f32 v30, v30, v42
    v_add_f32 v31, v31, v43
    v_add_f32 v20, v20, v44
    v_add_f32 v21, v21, v45
    v_add_f32 v22, v22, v46
    v_add_f32 v23, v23, v47
    v_add_f32 v24, v24, v48
    v_add_f32 v25, v25, v49
    v_add_f32 v26, v26, v50
    v_add_f32 v27, v27, v51
    v_add_f32 v28, v28, v52
    v_add_f32 v29, v29, v53
    v_add_f32 v30, v30, v54
    v_add_f32 v31, v31, v55
    v_add_f32 v20, v20, v56
    v_add_f32 v21, v21, v57
    v_add_f32 v22, v22, v58
    v_add_f32 v23, v23, v59
    v_add_f32 v24, v24, v60
    v_add_f32 v25, v25, v61
    v_add_f32 v26, v26, v62
    v_add_f32 v27, v27, v63
    v_add_f32 v28, v28, v64
    v_add_f32 v29, v29, v65
    v_add_f32 v30, v30, v66
    v_add_f32 v31, v31, v67
    v_add_f32 v68, v68, v80
    v_add_f32 v69, v69, v81
    v_add_f32 v70, v70, v82
    v_add_f32 v71, v71, v83
    v_add_f32 v72, v72, v84
    v_add_f32 v73, v73, v85
    v_add_f32 v74, v74, v86
    v_add_f32 v75, v75, v87
    v_add_f32 v76, v76, v88
    v_add_f32 v77, v77, v89
    v_add_f32 v78, v78, v90
    v_add_f32 v79, v79, v91
    v_add_f32 v68, v68, v92
    v_add_f32 v69, v69, v93
    v_add_f32 v70, v70, v94
    v_add_f32 v71, v71, v95
    v_add_f32 v72, v72, v96
    v_add_f32 v73, v73, v97
    v_add_f32 v74, v74, v98
    v_add_f32 v75, v75, v99
    v_add_f32 v76, v76, v100
    v_add_f32 v77, v77, v101
    v_add_f32 v78, v78, v102
    v_add_f32 v79, v79, v103
    v_add_f32 v68, v68, v104
    v_add_f32 v69, v69, v105
    v_add_f32 v70, v70, v106
    v_add_f32 v71, v71, v107
    v_add_f32 v72, v72, v108
    v_add_f32 v73, v73, v109
    v_add_f32 v74, v74, v110
    v_add_f32 v75, v75, v111
    v_add_f32 v76, v76, v112
    v_add_f32 v77, v77, v113
    v_add_f32 v78, v78, v114
    v_add_f32 v79, v79, v115
    s_waitcnt vmcnt(0)
    v_cvt_pk_bf16_f32 v32, v20, v21
    v_lshlrev_b32 v20, 16, v32
    v_and_b32 v21, 0xffff0000, v32
    v_cvt_pk_bf16_f32 v33, v22, v23
    v_lshlrev_b32 v22, 16, v33
    v_and_b32 v23, 0xffff0000, v33
    v_cvt_pk_bf16_f32 v34, v24, v25
    v_lshlrev_b32 v24, 16, v34
    v_and_b32 v25, 0xffff0000, v34
    v_cvt_pk_bf16_f32 v35, v26, v27
    v_lshlrev_b32 v26, 16, v35
    v_and_b32 v27, 0xffff0000, v35
    v_cvt_pk_bf16_f32 v36, v28, v29
    v_lshlrev_b32 v28, 16, v36
    v_and_b32 v29, 0xffff0000, v36
    v_cvt_pk_bf16_f32 v37, v30, v31
    v_lshlrev_b32 v30, 16, v37
    v_and_b32 v31, 0xffff0000, v37
    v_cvt_pk_bf16_f32 v32, v68, v69
    v_lshlrev_b32 v68, 16, v32
    v_and_b32 v69, 0xffff0000, v32
    v_cvt_pk_bf16_f32 v33, v70, v71
    v_lshlrev_b32 v70, 16, v33
    v_and_b32 v71, 0xffff0000, v33
    v_cvt_pk_bf16_f32 v34, v72, v73
    v_lshlrev_b32 v72, 16, v34
    v_and_b32 v73, 0xffff0000, v34
    v_cvt_pk_bf16_f32 v35, v74, v75
    v_lshlrev_b32 v74, 16, v35
    v_and_b32 v75, 0xffff0000, v35
    v_cvt_pk_bf16_f32 v36, v76, v77
    v_lshlrev_b32 v76, 16, v36
    v_and_b32 v77, 0xffff0000, v36
    v_cvt_pk_bf16_f32 v37, v78, v79
    v_lshlrev_b32 v78, 16, v37
    v_and_b32 v79, 0xffff0000, v37
    v_lshlrev_b32 v32, 16, v116
    v_and_b32 v33, 0xffff0000, v116
    v_lshlrev_b32 v34, 16, v117
    v_and_b32 v35, 0xffff0000, v117
    v_lshlrev_b32 v36, 16, v118
    v_and_b32 v37, 0xffff0000, v118
    v_lshlrev_b32 v38, 16, v119
    v_and_b32 v39, 0xffff0000, v119
    v_lshlrev_b32 v40, 16, v120
    v_and_b32 v41, 0xffff0000, v120
    v_lshlrev_b32 v42, 16, v121
    v_and_b32 v43, 0xffff0000, v121
    v_add_f32 v20, v32, v20
    v_add_f32 v21, v33, v21
    v_add_f32 v22, v34, v22
    v_add_f32 v23, v35, v23
    v_add_f32 v24, v36, v24
    v_add_f32 v25, v37, v25
    v_add_f32 v26, v38, v26
    v_add_f32 v27, v39, v27
    v_add_f32 v28, v40, v28
    v_add_f32 v29, v41, v29
    v_add_f32 v30, v42, v30
    v_add_f32 v31, v43, v31
    v_cvt_pk_bf16_f32 v32, v20, v21
    v_lshlrev_b32 v20, 16, v32
    v_and_b32 v21, 0xffff0000, v32
    v_cvt_pk_bf16_f32 v33, v22, v23
    v_lshlrev_b32 v22, 16, v33
    v_and_b32 v23, 0xffff0000, v33
    v_cvt_pk_bf16_f32 v34, v24, v25
    v_lshlrev_b32 v24, 16, v34
    v_and_b32 v25, 0xffff0000, v34
    v_cvt_pk_bf16_f32 v35, v26, v27
    v_lshlrev_b32 v26, 16, v35
    v_and_b32 v27, 0xffff0000, v35
    v_cvt_pk_bf16_f32 v36, v28, v29
    v_lshlrev_b32 v28, 16, v36
    v_and_b32 v29, 0xffff0000, v36
    v_cvt_pk_bf16_f32 v37, v30, v31
    v_lshlrev_b32 v30, 16, v37
    v_and_b32 v31, 0xffff0000, v37
    v_add_f32 v20, v20, v68
    v_add_f32 v21, v21, v69
    v_add_f32 v22, v22, v70
    v_add_f32 v23, v23, v71
    v_add_f32 v24, v24, v72
    v_add_f32 v25, v25, v73
    v_add_f32 v26, v26, v74
    v_add_f32 v27, v27, v75
    v_add_f32 v28, v28, v76
    v_add_f32 v29, v29, v77
    v_add_f32 v30, v30, v78
    v_add_f32 v31, v31, v79
    v_cvt_pk_bf16_f32 v116, v20, v21
    v_cvt_pk_bf16_f32 v117, v22, v23
    v_cvt_pk_bf16_f32 v118, v24, v25
    v_cvt_pk_bf16_f32 v119, v26, v27
    v_cvt_pk_bf16_f32 v120, v28, v29
    v_cvt_pk_bf16_f32 v121, v30, v31
    buffer_store_dwordx2 v[116:117], v14, s[16:19], s46 offen offset:0
    buffer_store_dwordx2 v[118:119], v14, s[16:19], s46 offen offset:32
    s_cmp_lg_u32 s30, 0
    s_cbranch_scc1 k4_end
    buffer_store_dwordx2 v[120:121], v14, s[16:19], s46 offen offset:64
k4_end:
k4_done:
    s_endpgm
.section .rodata,"a"
.p2align 6

.amdhsa_kernel k1_kernel
  .amdhsa_next_free_vgpr 256
  .amdhsa_next_free_sgpr 100
  .amdhsa_accum_offset 256
  .amdhsa_group_segment_fixed_size 0
  .amdhsa_kernarg_size 88
  .amdhsa_user_sgpr_count 2
  .amdhsa_user_sgpr_kernarg_segment_ptr 1
  .amdhsa_system_sgpr_workgroup_id_x 1
.end_amdhsa_kernel

.amdhsa_kernel k2_kernel
  .amdhsa_next_free_vgpr 256
  .amdhsa_next_free_sgpr 100
  .amdhsa_accum_offset 256
  .amdhsa_group_segment_fixed_size 0
  .amdhsa_kernarg_size 88
  .amdhsa_user_sgpr_count 2
  .amdhsa_user_sgpr_kernarg_segment_ptr 1
  .amdhsa_system_sgpr_workgroup_id_x 1
.end_amdhsa_kernel

.amdhsa_kernel k3_kernel
  .amdhsa_next_free_vgpr 256
  .amdhsa_next_free_sgpr 100
  .amdhsa_accum_offset 128
  .amdhsa_group_segment_fixed_size 0
  .amdhsa_kernarg_size 88
  .amdhsa_user_sgpr_count 2
  .amdhsa_user_sgpr_kernarg_segment_ptr 1
  .amdhsa_system_sgpr_workgroup_id_x 1
.end_amdhsa_kernel

.amdhsa_kernel k4_kernel
  .amdhsa_next_free_vgpr 256
  .amdhsa_next_free_sgpr 100
  .amdhsa_accum_offset 128
  .amdhsa_group_segment_fixed_size 0
  .amdhsa_kernarg_size 88
  .amdhsa_user_sgpr_count 2
  .amdhsa_user_sgpr_kernarg_segment_ptr 1
  .amdhsa_system_sgpr_workgroup_id_x 1
.end_amdhsa_kernel
```
